```python
import torch

def _softmax(x, axis=-1):
    return torch.softmax(x, dim=axis)

def _gelu(x):
    return torch.nn.functional.gelu(x, approximate='tanh')

def _silu(x):
    return torch.nn.functional.silu(x)

def _sigmoid(x):
    return torch.sigmoid(x)

def _layernorm(x, axis=-1, eps=1e-05):
    m = x.mean(dim=axis, keepdim=True)
    v = x.var(dim=axis, keepdim=True, unbiased=False)
    return (x - m) / torch.sqrt(v + eps)

def _scatter_add(tgt, idx, src, axis=0):
    return tgt.clone().index_add_(axis, idx, src)

def _segment_sum(src, seg, n):
    out = torch.zeros((n,) + src.shape[1:], dtype=src.dtype)
    return out.index_add_(0, seg, src)

def _pad(x, pw):
    flat = tuple((v for pair in reversed(pw) for v in pair))
    return torch.nn.functional.pad(x, flat)
kernel_name = 'adaLN_cond__ssm_conv_h3__mixer_s_mlp__prompt'

def setup_inputs():

    _w = lambda a: (lambda t: t.to(torch.bfloat16) if t.is_floating_point() else t)(torch.as_tensor(a))

    def _A_setup():
        B, S, D = (1, 2048, 512)
        ks = 4
        return {'q': _w((lambda *s: torch.randn(*s, dtype=torch.bfloat16) * 0.05)(B, S, D)), 'k': _w((lambda *s: torch.randn(*s, dtype=torch.bfloat16) * 0.8)(B, S, D)), 'v': _w((lambda *s: torch.randn(*s, dtype=torch.bfloat16) * 0.8)(B, S, D)), 'shift_k': _w((lambda *s: torch.randn(*s, dtype=torch.bfloat16) * 0.8)(D, ks) * 0.5), 'ssm_k': _w((lambda *s: torch.randn(*s, dtype=torch.bfloat16) * 0.8)(D, S) * (1.0 / S ** 0.5)), 'ssm_D': _w((lambda *s: torch.randn(*s, dtype=torch.bfloat16) * 0.8)(D))}
    _A_in = _A_setup()

    def _B_setup():
        B, S, D, F = (1, 2048, 512, 1792)
        return {'x': _w((lambda *s: torch.randn(*s, dtype=torch.bfloat16) * 0.05)(B, S, D)), 'w1': _w((lambda *s: torch.randn(*s, dtype=torch.bfloat16) * 3.2)(D, D) * D ** (-0.5)), 'w2': _w((lambda *s: torch.randn(*s, dtype=torch.bfloat16) * 3.2)(D, D) * D ** (-0.5)), 'w3': _w((lambda *s: torch.randn(*s, dtype=torch.bfloat16) * 3.2)(D, F) * D ** (-0.5)), 'w4': _w((lambda *s: torch.randn(*s, dtype=torch.bfloat16) * 3.2)(F, D) * F ** (-0.5))}
    _B_in = _B_setup()
    return {'A_q': _A_in['q'], 'A_k': _A_in['k'], 'A_v': _A_in['v'], 'A_shift_k': _A_in['shift_k'], 'A_ssm_k': _A_in['ssm_k'], 'A_ssm_D': _A_in['ssm_D'], 'B_x': _B_in['x'], 'B_w1': _B_in['w1'], 'B_w2': _B_in['w2'], 'B_w3': _B_in['w3'], 'B_w4': _B_in['w4'], 'c': _w((lambda *s: torch.randn(*s, dtype=torch.bfloat16) * 0.1)(1, 512) * 8.0), 'w_mod': _w((lambda *s: torch.randn(*s, dtype=torch.bfloat16) * 0.1)(512, 6 * 512) * 512 ** (-0.5) * 8.0)}

def reference(A_q, A_k, A_v, A_shift_k, A_ssm_k, A_ssm_D, B_x, B_w1, B_w2, B_w3, B_w4, c, w_mod):

    def _A_ref(q, k, v, shift_k, ssm_k, ssm_D):
        B, S, D = q.shape
        ks = shift_k.shape[-1]
        k_pad = _pad(k, ((0, 0), (ks - 1, 0), (0, 0)))
        k_shift = torch.zeros_like(k)
        for t in range(ks):
            k_shift = k_shift + k_pad[:, t:t + S, :] * shift_k[:, ks - 1 - t][None, None, :]
        kv = k_shift * v
        L = 2 * S
        kv_pad = _pad(kv, ((0, 0), (0, S), (0, 0)))
        kf_pad = _pad(ssm_k, ((0, 0), (0, S)))
        kv_f = (lambda x, axes=(-2, -1): torch.fft.rfft2(x.float(), dim=axes))(kv_pad[:, None, :, :], axes=(1, 2))
        kf_f = (lambda x, axes=(-2, -1): torch.fft.rfft2(x.float(), dim=axes))(kf_pad[:, None, :], axes=(1, 2))
        kf_f = (lambda x, *d: x.permute(*d))(kf_f, 1, 2, 0)
        y_f = kv_f * kf_f[None, :, :, :]
        y = (lambda x, s, axes=(-2, -1): torch.fft.irfft2(x, s=s, dim=axes).to(torch.bfloat16))(y_f, (1, L), axes=(1, 2))[:, 0, :S, :]
        y = y + kv * ssm_D[None, None, :]
        return q * y

    def _B_ref(x, w1, w2, w3, w4):
        B, S, D = x.shape
        h = _gelu(_layernorm(x, axis=-1) @ w1)
        c = D // 4
        g0 = _pad(h[:, :, 0 * c:1 * c], ((0, 0), (1, 0), (0, 0)))[:, :S, :]
        g1 = _pad(h[:, :, 1 * c:2 * c], ((0, 0), (0, 1), (0, 0)))[:, 1:, :]
        g2 = _pad(h[:, :, 2 * c:3 * c], ((0, 0), (2, 0), (0, 0)))[:, :S, :]
        g3 = _pad(h[:, :, 3 * c:], ((0, 0), (0, 2), (0, 0)))[:, 2:, :]
        hs = torch.concatenate([g0, g1, g2, g3], axis=-1) @ w2
        x1 = x + hs
        h2 = _gelu(_layernorm(x1, axis=-1) @ w3) @ w4
        return x1 + h2
    x = A_q
    mod = (_silu(c) @ w_mod).reshape(c.shape[0], 6, 1, -1)
    sa, ca, ga, sb, cb, gb = (mod[:, 0].clone(), mod[:, 1].clone(), mod[:, 2].clone(), mod[:, 3].clone(), mod[:, 4].clone(), mod[:, 5].clone())
    h = _layernorm(x, axis=-1) * (1 + ca) + sa
    x = x + ga * _A_ref(h, A_k, A_v, A_shift_k, A_ssm_k, A_ssm_D)
    h = _layernorm(x, axis=-1) * (1 + cb) + sb
    x = x + gb * _B_ref(h, B_w1, B_w2, B_w3, B_w4)
    return x
```

```asm
; @launch grid=(256,1,1) block=(512,1,1) lds=163840
.amdgcn_target "amdgcn-amd-amdhsa--gfx950"
.text
.globl adaLN_cond__ssm_conv_h3__mixer_s_mlp__prompt_kernel
.p2align 8
.type adaLN_cond__ssm_conv_h3__mixer_s_mlp__prompt_kernel,@function
adaLN_cond__ssm_conv_h3__mixer_s_mlp__prompt_kernel:
L_start:
  s_load_dwordx2 s[12:13], s[0:1], 8
  s_load_dwordx2 s[16:17], s[0:1], 16
  s_cmp_ge_u32 s2, 256
  s_cbranch_scc1 L_end
  s_getpc_b64 s[4:5]
L_pc:
  s_lshr_b32 s6, s2, 3
  s_add_u32 s6, s6, s2
  s_and_b32 s6, s6, 3
  s_lshl_b32 s6, s6, 7
  v_lshrrev_b32 v7, 3, v0
  v_lshl_add_u32 v7, v7, 9, s6
  v_min_u32 v7, L_end-L_pc-16, v7
  global_load_dword v127, v7, s[4:5]
  s_lshr_b32 s88, s2, 6
  s_and_b32 s89, s2, 63
  v_and_b32 v1, 63, v0
  v_lshrrev_b32 v2, 6, v0
  s_lshl_b32 s6, s89, 15
  s_lshl_b32 s7, s88, 8
  s_add_u32 s6, s6, s7
  v_lshl_add_u32 v5, v1, 2, s6
  v_lshl_add_u32 v5, v2, 12, v5
  v_subrev_u32 v6, 3072, v5
  s_mov_b32 s14, 2097152
  s_mov_b32 s15, 0x20000
  s_mov_b32 s18, s14
  s_mov_b32 s19, s15
  s_waitcnt lgkmcnt(0)
  buffer_load_dword v64, v6, s[12:15], 0 offen offset:0
  buffer_load_dword v65, v6, s[12:15], 0 offen offset:1024
  buffer_load_dword v66, v6, s[12:15], 0 offen offset:2048
  buffer_load_dword v67, v5, s[12:15], 0 offen offset:0
  buffer_load_dword v68, v5, s[12:15], 0 offen offset:1024
  buffer_load_dword v69, v5, s[12:15], 0 offen offset:2048
  buffer_load_dword v70, v5, s[12:15], 0 offen offset:3072
  buffer_load_dword v71, v5, s[16:19], 0 offen offset:0
  buffer_load_dword v72, v5, s[16:19], 0 offen offset:1024
  buffer_load_dword v73, v5, s[16:19], 0 offen offset:2048
  buffer_load_dword v74, v5, s[16:19], 0 offen offset:3072
  s_load_dwordx2 s[20:21], s[0:1], 24
  s_load_dwordx2 s[8:9], s[0:1], 120
  s_load_dwordx2 s[24:25], s[0:1], 88
  s_load_dwordx2 s[28:29], s[0:1], 96
  s_load_dwordx2 s[32:33], s[0:1], 32
  s_load_dwordx2 s[36:37], s[0:1], 40
  s_load_dwordx2 s[40:41], s[0:1], 56
  s_load_dwordx2 s[44:45], s[0:1], 64
  s_load_dwordx2 s[48:49], s[0:1], 0
  s_load_dwordx4 s[64:67], s[0:1], 72
  v_readfirstlane_b32 s3, v2
  s_mov_b32 s22, 4096
  s_mov_b32 s23, s15
  s_mov_b32 s10, 33554432
  s_mov_b32 s11, s15
  s_mov_b32 s26, 1024
  s_mov_b32 s27, s15
  s_mov_b32 s30, 3145728
  s_mov_b32 s31, s15
  s_mov_b32 s34, 2097152
  s_mov_b32 s35, s15
  s_mov_b32 s38, 1024
  s_mov_b32 s39, s15
  s_mov_b32 s42, 524288
  s_mov_b32 s43, s15
  s_mov_b32 s46, 524288
  s_mov_b32 s47, s15
  s_mov_b32 s50, 2097152
  s_mov_b32 s51, s15
  s_mov_b32 s55, s15
  v_lshlrev_b32 v2, 4, v1
  s_lshl_b32 s7, s88, 10
  s_waitcnt lgkmcnt(0)
  buffer_load_dwordx4 v[76:79], v2, s[20:23], s7 offen
  v_and_b32 v3, 31, v1
  s_getreg_b32 s62, hwreg(HW_REG_XCC_ID)
  s_and_b32 s62, s62, 7
  v_lshrrev_b32 v4, 5, v1
  v_mov_b32 v8, 0x3f803f80
  v_mov_b32 v9, v8
  v_mov_b32 v10, v8
  v_mov_b32 v11, v8
  v_mov_b32 v12, 0xbdd2d3e8
  v_mov_b32 v14, 2146435072
  v_writelane_b32 v14, 0, 0
  s_mov_b32 s4, 2555904
  buffer_load_dword v124, v14, s[8:11], s4 offen sc1
  s_lshr_b32 s68, s3, 2
  s_and_b32 s69, s3, 3
  s_and_b32 s70, s3, 1
  s_lshl_b32 s6, s2, 2
  s_lshl_b32 s7, s68, 1
  s_add_u32 s6, s6, s7
  v_mov_b32 v7, s6
  buffer_load_ushort v47, v7, s[36:39], 0 offen
  v_and_b32 v41, 3, v1
  v_lshlrev_b32 v41, 3, v41
  v_bfe_u32 v42, v1, 2, 2
  v_lshl_add_u32 v42, v4, 2, v42
  v_lshl_add_u32 v41, v42, 7, v41
  v_bfe_u32 v42, v1, 4, 1
  v_lshl_add_u32 v41, v42, 5, v41
  v_mov_b32 v13, v41
  s_lshr_b32 s90, s2, 3
  s_and_b32 s91, s2, 7
  s_movk_i32 s92, 1024
  s_lshl_b32 s93, s90, 14
  s_lshl_b32 s6, s91, 7
  s_add_u32 s93, s93, s6
  s_lshl_b32 s76, s91, 16
  s_lshl_b32 s6, s90, 10
  s_add_u32 s76, s76, s6
  s_lshl_b32 s6, s3, 19
  s_add_u32 s76, s76, s6
  s_add_u32 s76, s76, 3145728
  s_and_b32 s6, s3, 1
  s_lshl_b32 s75, s6, 11
  s_add_u32 s75, s75, 81920
  s_mov_b32 s77, 32768
  s_cmp_eq_u32 s3, 1
  s_cselect_b64 s[40:41], s[44:45], s[40:41]
  s_cmp_gt_u32 s3, 1
  s_cbranch_scc1 L_now12
  v_lshrrev_b32 v6, 3, v1
  v_mul_lo_u32 v6, v6, s92
  v_and_b32 v7, 7, v1
  v_lshl_add_u32 v6, v7, 4, v6
  s_mov_b32 m0, s75
  s_lshl_b32 s4, s92, 3
  s_add_u32 s4, s4, s93
  s_sub_u32 s4, s4, 1024
  buffer_load_dwordx4 v6, s[40:43], s93 offen lds
  buffer_load_dwordx4 v6, s[40:43], s4 offen offset:1024 lds
L_now12:
  s_nop 1
  s_lshl_b32 s6, s2, 1
  s_add_u32 s6, s6, s68
  s_lshl_b32 s78, s6, 12
  s_lshl_b32 s7, s69, 1
  s_add_u32 s79, s7, s78
  s_mul_i32 s80, s3, 4160
  s_add_u32 s80, s80, 9472
  v_add_u32 v5, s69, v1
  v_subrev_u32 v5, 16, v5
  v_lshlrev_b32 v33, 1, v5
  v_and_b32 v5, 0x80000000, v5
  v_or_b32 v33, v33, v5
  s_add_u32 m0, s80, 32
  s_nop 0
  buffer_load_dwordx4 v2, s[32:35], s79 offen offset:0 lds
  buffer_load_dwordx4 v2, s[32:35], s79 offen offset:1024 lds
  buffer_load_dwordx4 v2, s[32:35], s79 offen offset:2048 lds
  buffer_load_dwordx4 v2, s[32:35], s79 offen offset:3072 lds
  buffer_load_ushort v32, v33, s[32:35], s78 offen
  s_lshr_b32 s6, s3, 1
  s_lshl_b32 s6, s6, 4
  s_and_b32 s7, s3, 1
  s_xor_b32 s7, s7, 1
  s_lshl_b32 s7, s7, 3
  s_add_u32 s6, s6, s7
  s_lshr_b32 s7, s89, 1
  s_and_b32 s7, s7, 1
  s_lshl_b32 s7, s7, 6
  s_add_u32 s4, s6, s7
  s_xor_b32 s7, s7, 64
  s_add_u32 s5, s6, s7
  v_mul_u32_u24 v7, 144, v1
  v_add_u32 v16, s4, v7
  v_add_u32 v17, s5, v7
  v_lshrrev_b32 v7, 3, v0
  v_and_b32 v5, 7, v0
  v_mul_u32_u24 v18, 144, v7
  v_lshl_add_u32 v18, v5, 4, v18
  v_lshlrev_b32 v19, 13, v7
  v_lshl_add_u32 v19, v5, 4, v19
  s_lshl_b32 s81, s88, 19
  s_lshl_b32 s7, s89, 7
  s_add_u32 s81, s81, s7
  s_waitcnt vmcnt(18)
  v_lshlrev_b32 v80, 16, v64
  v_and_b32 v88, 0xffff0000, v64
  s_waitcnt vmcnt(17)
  v_lshlrev_b32 v81, 16, v65
  v_and_b32 v89, 0xffff0000, v65
  s_waitcnt vmcnt(16)
  v_lshlrev_b32 v82, 16, v66
  v_and_b32 v90, 0xffff0000, v66
  s_waitcnt vmcnt(15)
  v_lshlrev_b32 v83, 16, v67
  v_and_b32 v91, 0xffff0000, v67
  s_waitcnt vmcnt(14)
  v_lshlrev_b32 v84, 16, v68
  v_and_b32 v92, 0xffff0000, v68
  s_waitcnt vmcnt(13)
  v_lshlrev_b32 v85, 16, v69
  v_and_b32 v93, 0xffff0000, v69
  s_waitcnt vmcnt(12)
  v_lshlrev_b32 v86, 16, v70
  v_and_b32 v94, 0xffff0000, v70
  s_waitcnt vmcnt(7)
  v_lshlrev_b32 v104, 16, v76
  v_and_b32 v105, 0xffff0000, v76
  v_lshlrev_b32 v106, 16, v77
  v_and_b32 v107, 0xffff0000, v77
  v_lshlrev_b32 v108, 16, v78
  v_and_b32 v109, 0xffff0000, v78
  v_lshlrev_b32 v110, 16, v79
  v_and_b32 v111, 0xffff0000, v79
  v_lshlrev_b32 v96, 16, v71
  v_and_b32 v100, 0xffff0000, v71
  v_lshlrev_b32 v97, 16, v72
  v_and_b32 v101, 0xffff0000, v72
  v_lshlrev_b32 v98, 16, v73
  v_and_b32 v102, 0xffff0000, v73
  v_lshlrev_b32 v99, 16, v74
  v_and_b32 v103, 0xffff0000, v74
  v_mul_f32 v112, v80, v107
  v_mul_f32 v113, v81, v107
  v_mul_f32 v114, v82, v107
  v_mul_f32 v115, v83, v107
  v_fmac_f32 v112, v81, v106
  v_fmac_f32 v113, v82, v106
  v_fmac_f32 v114, v83, v106
  v_fmac_f32 v115, v84, v106
  v_fmac_f32 v112, v82, v105
  v_fmac_f32 v113, v83, v105
  v_fmac_f32 v114, v84, v105
  v_fmac_f32 v115, v85, v105
  v_fmac_f32 v112, v83, v104
  v_fmac_f32 v113, v84, v104
  v_fmac_f32 v114, v85, v104
  v_fmac_f32 v115, v86, v104
  v_mul_f32 v112, v112, v96
  v_mul_f32 v113, v113, v97
  v_mul_f32 v114, v114, v98
  v_mul_f32 v115, v115, v99
  v_cvt_pk_bf16_f32 v120, v115, v114
  v_cvt_pk_bf16_f32 v121, v113, v112
  ds_write_b64 v16, v[120:121] offset:42752
  v_mul_f32 v116, v88, v111
  v_mul_f32 v117, v89, v111
  v_mul_f32 v118, v90, v111
  v_mul_f32 v119, v91, v111
  v_fmac_f32 v116, v89, v110
  v_fmac_f32 v117, v90, v110
  v_fmac_f32 v118, v91, v110
  v_fmac_f32 v119, v92, v110
  v_fmac_f32 v116, v90, v109
  v_fmac_f32 v117, v91, v109
  v_fmac_f32 v118, v92, v109
  v_fmac_f32 v119, v93, v109
  v_fmac_f32 v116, v91, v108
  v_fmac_f32 v117, v92, v108
  v_fmac_f32 v118, v93, v108
  v_fmac_f32 v119, v94, v108
  v_mul_f32 v116, v116, v100
  v_mul_f32 v117, v117, v101
  v_mul_f32 v118, v118, v102
  v_mul_f32 v119, v119, v103
  v_cvt_pk_bf16_f32 v122, v119, v118
  v_cvt_pk_bf16_f32 v123, v117, v116
  ds_write_b64 v17, v[122:123] offset:42752
  s_waitcnt lgkmcnt(0)
  s_barrier
  ds_read_b128 v[20:23], v18 offset:42752
  s_waitcnt lgkmcnt(0)
  buffer_store_dwordx4 v[20:23], v19, s[8:11], s81 offen sc1
  s_cmp_gt_u32 s3, 1
  s_cbranch_scc1 L_nop12
  s_waitcnt vmcnt(1)
  v_add_u32 v72, s75, v41
  ds_read_b64_tr_b16 v[64:65], v72 offset:0
  ds_read_b64_tr_b16 v[66:67], v72 offset:1024
  ds_read_b64_tr_b16 v[68:69], v72 offset:64
  ds_read_b64_tr_b16 v[70:71], v72 offset:1088
  s_add_u32 s4, s76, s77
  s_waitcnt lgkmcnt(2)
  buffer_store_dwordx4 v[64:67], v2, s[8:11], s76 offen sc1
  s_waitcnt lgkmcnt(0)
  buffer_store_dwordx4 v[68:71], v2, s[8:11], s4 offen sc1
L_nop12:
  s_nop 1
  s_mul_i32 s90, s2, 7
  s_min_u32 s7, s3, 6
  s_add_u32 s90, s90, s7
  s_lshl_b32 s72, s3, 11
  s_add_u32 s72, s72, 65536
  s_cmp_ge_u32 s90, 896
  s_cbranch_scc1 L_p4
  s_mov_b64 s[44:45], s[64:65]
  s_mul_i32 s91, s90, 2341
  s_lshr_b32 s91, s91, 16
  s_mul_i32 s92, s91, 28
  s_sub_u32 s92, s90, s92
  s_movk_i32 s93, 3584
  s_mov_b32 s74, 32768
  s_mov_b32 s73, 4194304
  s_branch L_pj
L_p4:
  s_mov_b64 s[44:45], s[66:67]
  s_sub_u32 s90, s90, 896
  s_lshr_b32 s91, s90, 3
  s_and_b32 s92, s90, 7
  s_movk_i32 s93, 1024
  s_mov_b32 s74, 114688
  s_mov_b32 s73, 6291456
L_pj:
  s_mov_b32 s46, 1835008
  s_mul_i32 s94, s91, s93
  s_lshl_b32 s94, s94, 4
  s_lshl_b32 s7, s92, 7
  s_add_u32 s94, s94, s7
  s_mul_i32 s7, s92, s74
  s_lshl_b32 s7, s7, 1
  s_add_u32 s73, s73, s7
  s_lshl_b32 s7, s91, 10
  s_add_u32 s73, s73, s7
  s_cmp_eq_u32 s3, 7
  s_cselect_b32 s73, 2146435072, s73
  s_cselect_b32 s94, 2146435072, s94
  s_mul_i32 s92, s2, 1366
  s_lshr_b32 s92, s92, 16
  s_mul_i32 s6, s92, 48
  s_sub_u32 s7, s2, s6
  v_lshrrev_b32 v5, 3, v0
  s_lshl_b32 s6, s92, 7
  v_add_u32 v5, s6, v5
  v_lshlrev_b32 v242, 1, v5
  s_movk_i32 s6, 6144
  v_mul_lo_u32 v5, v5, s6
  v_and_b32 v6, 7, v0
  v_lshl_add_u32 v243, v6, 4, v5
  s_lshl_b32 s90, s7, 7
  s_add_u32 s91, s90, 393216
  s_lshl_b32 s6, s7, 10
  s_lshl_b32 s7, s92, 2
  s_add_u32 s6, s6, s7
  s_add_u32 s92, s6, 2097152
  s_cmp_ge_u32 s2, 192
  s_cselect_b32 s92, 2146435072, s92
  s_cmp_lg_u32 s3, 0
  s_cselect_b32 s92, 2146435072, s92
  s_and_b32 s4, s2, 7
  s_lshl_b32 s4, s4, 5
  s_lshr_b32 s5, s2, 3
  s_add_u32 s61, s4, s5
  s_lshr_b32 s4, s61, 5
  s_and_b32 s5, s61, 31
  s_lshl_b32 s57, s4, 3
  s_lshr_b32 s6, s5, 2
  s_add_u32 s57, s57, s6
  s_and_b32 s58, s5, 3
  s_lshl_b32 s59, s4, 2
  s_lshr_b32 s6, s5, 3
  s_add_u32 s59, s59, s6
  s_and_b32 s60, s5, 7
  s_mul_i32 s96, s59, 458752
  s_lshl_b32 s6, s57, 15
  s_lshl_b32 s95, s3, 12
  s_lshl_b32 s7, s3, 7
  s_add_u32 s71, s6, s7
  v_lshrrev_b32 v5, 4, v1
  v_xor_b32 v5, v5, v1
  v_and_b32 v5, 7, v5
  v_lshlrev_b32 v5, 4, v5
  v_lshrrev_b32 v6, 3, v1
  v_lshl_add_u32 v244, v6, 10, v5
  v_xor_b32 v245, 64, v244
  v_mov_b32 v24, 0
  v_mov_b32 v25, 0
  v_mov_b32 v26, 0
  v_mov_b32 v27, 0
  ds_write_b128 v2, v[24:27]
  ds_write_b128 v2, v[24:27] offset:256
  v_mov_b32 v6, 161792
  ds_write_b128 v6, v[24:27]
  v_and_b32 v42, 15, v1
  v_lshrrev_b32 v43, 4, v1
  v_lshl_add_u32 v40, v43, 3, v42
  v_add_u32 v40, 1, v40
  v_and_b32 v6, 3, v40
  v_and_b32 v40, 0xfc, v40
  v_lshlrev_b32 v40, 1, v40
  v_mul_u32_u24 v6, 4160, v6
  v_add_u32 v40, v40, v6
  s_mul_i32 s6, s68, 16640
  s_lshl_b32 s7, s70, 6
  s_add_u32 s6, s6, s7
  s_add_u32 s6, s6, 9472
  v_add_u32 v40, s6, v40
  v_lshlrev_b32 v6, 1, v42
  v_sub_u32 v6, v6, v43
  v_add_u32 v6, 1, v6
  s_lshl_b32 s7, s70, 2
  s_add_i32 s7, s7, -32
  v_add_u32 v44, s7, v6
  v_ashrrev_i32 v45, 2, v44
  v_lshlrev_b32 v45, 7, v45
  v_and_b32 v46, 3, v44
  v_lshl_add_u32 v45, v46, 4, v45
  v_bfe_u32 v46, v44, 3, 1
  v_xor_b32 v46, s68, v46
  v_lshl_add_u32 v45, v46, 6, v45
  v_add_u32 v60, 1280, v45
  s_lshl_b32 s7, s70, 2
  s_add_i32 s7, s7, -24
  v_add_u32 v44, s7, v6
  v_ashrrev_i32 v45, 2, v44
  v_lshlrev_b32 v45, 7, v45
  v_and_b32 v46, 3, v44
  v_lshl_add_u32 v45, v46, 4, v45
  v_bfe_u32 v46, v44, 3, 1
  v_xor_b32 v46, s68, v46
  v_lshl_add_u32 v45, v46, 6, v45
  v_add_u32 v61, 1280, v45
  v_sub_u32 v44, 15, v42
  v_lshlrev_b32 v45, 3, v43
  v_sub_u32 v44, v44, v45
  s_cmp_lg_u32 s70, 0
  s_cselect_b32 s7, 0, -1
  s_waitcnt vmcnt(6)
  v_and_b32 v47, s7, v47
  v_lshlrev_b32 v45, 16, v47
  v_cmp_eq_u32 vcc, 0, v44
  s_nop 1
  v_cndmask_b32 v56, 0, v47, vcc
  v_cmp_eq_u32 vcc, 1, v44
  s_nop 1
  v_cndmask_b32 v56, v56, v45, vcc
  v_cmp_eq_u32 vcc, 2, v44
  s_nop 1
  v_cndmask_b32 v57, 0, v47, vcc
  v_cmp_eq_u32 vcc, 3, v44
  s_nop 1
  v_cndmask_b32 v57, v57, v45, vcc
  v_cmp_eq_u32 vcc, 4, v44
  s_nop 1
  v_cndmask_b32 v58, 0, v47, vcc
  v_cmp_eq_u32 vcc, 5, v44
  s_nop 1
  v_cndmask_b32 v58, v58, v45, vcc
  v_cmp_eq_u32 vcc, 6, v44
  s_nop 1
  v_cndmask_b32 v59, 0, v47, vcc
  v_cmp_eq_u32 vcc, 7, v44
  s_nop 1
  v_cndmask_b32 v59, v59, v45, vcc
  v_lshrrev_b32 v62, 1, v42
  v_mul_u32_u24 v62, 144, v62
  v_and_b32 v44, 1, v42
  v_lshl_add_u32 v62, v44, 5, v62
  v_lshl_add_u32 v62, v43, 3, v62
  s_lshl_b32 s6, s68, 6
  v_add_u32 v62, s6, v62
  v_lshlrev_b32 v5, 1, v1
  v_add_u32 v5, s80, v5
  s_waitcnt vmcnt(1)
  ds_write_b16 v5, v32
  v_readfirstlane_b32 s56, v124
  s_nop 0
  s_mul_i32 s56, s56, 0x9e3779b1
  s_add_u32 s56, s56, 0x7f4a7c15
  s_waitcnt vmcnt(0)
  s_waitcnt lgkmcnt(0)
  s_barrier
  s_lshl_b32 s4, s2, 4
  s_add_u32 s4, s4, 2359296
  s_cmp_lg_u32 s3, 0
  s_cselect_b32 s4, 2146435072, s4
  v_mov_b32 v5, s56
  buffer_store_dword v5, v14, s[8:11], s4 offen sc1
  buffer_load_ushort v246, v242, s[24:27], 0 offen
  buffer_load_ushort v247, v242, s[24:27], 0 offen offset:128
  buffer_load_dwordx4 v[248:251], v243, s[28:31], s90 offen
  buffer_load_dwordx4 v[252:255], v243, s[28:31], s91 offen
  ds_read_b64 v[64:65], v40 offset:0
  ds_read_b64 v[66:67], v40 offset:8
  ds_read_b64 v[68:69], v40 offset:128
  ds_read_b64 v[70:71], v40 offset:136
  ds_read_b64 v[72:73], v40 offset:256
  ds_read_b64 v[74:75], v40 offset:264
  ds_read_b64 v[76:77], v40 offset:384
  ds_read_b64 v[78:79], v40 offset:392
  ds_read_b64 v[80:81], v40 offset:512
  ds_read_b64 v[82:83], v40 offset:520
  ds_read_b64 v[84:85], v40 offset:640
  ds_read_b64 v[86:87], v40 offset:648
  ds_read_b64 v[88:89], v40 offset:768
  ds_read_b64 v[90:91], v40 offset:776
  ds_read_b64 v[92:93], v40 offset:896
  ds_read_b64 v[94:95], v40 offset:904
  ds_read_b64 v[96:97], v40 offset:1024
  ds_read_b64 v[98:99], v40 offset:1032
  ds_read_b64 v[100:101], v40 offset:1152
  ds_read_b64 v[102:103], v40 offset:1160
  ds_read_b64 v[104:105], v40 offset:1280
  ds_read_b64 v[106:107], v40 offset:1288
  ds_read_b64 v[108:109], v40 offset:1408
  ds_read_b64 v[110:111], v40 offset:1416
  ds_read_b64 v[112:113], v40 offset:1536
  ds_read_b64 v[114:115], v40 offset:1544
  ds_read_b64 v[116:117], v40 offset:1664
  ds_read_b64 v[118:119], v40 offset:1672
  ds_read_b64 v[120:121], v40 offset:1792
  ds_read_b64 v[122:123], v40 offset:1800
  ds_read_b64 v[124:125], v40 offset:1920
  ds_read_b64 v[126:127], v40 offset:1928
  ds_read_b64 v[128:129], v40 offset:2048
  ds_read_b64 v[130:131], v40 offset:2056
  ds_read_b64 v[132:133], v40 offset:2176
  ds_read_b64 v[134:135], v40 offset:2184
  ds_read_b64 v[136:137], v40 offset:2304
  ds_read_b64 v[138:139], v40 offset:2312
  ds_read_b64 v[140:141], v40 offset:2432
  ds_read_b64 v[142:143], v40 offset:2440
  ds_read_b64 v[144:145], v40 offset:2560
  ds_read_b64 v[146:147], v40 offset:2568
  ds_read_b64 v[148:149], v40 offset:2688
  ds_read_b64 v[150:151], v40 offset:2696
  ds_read_b64 v[152:153], v40 offset:2816
  ds_read_b64 v[154:155], v40 offset:2824
  ds_read_b64 v[156:157], v40 offset:2944
  ds_read_b64 v[158:159], v40 offset:2952
  ds_read_b64 v[160:161], v40 offset:3072
  ds_read_b64 v[162:163], v40 offset:3080
  ds_read_b64 v[164:165], v40 offset:3200
  ds_read_b64 v[166:167], v40 offset:3208
  ds_read_b64 v[168:169], v40 offset:3328
  ds_read_b64 v[170:171], v40 offset:3336
  ds_read_b64 v[172:173], v40 offset:3456
  ds_read_b64 v[174:175], v40 offset:3464
  ds_read_b64 v[176:177], v40 offset:3584
  ds_read_b64 v[178:179], v40 offset:3592
  ds_read_b64 v[180:181], v40 offset:3712
  ds_read_b64 v[182:183], v40 offset:3720
  ds_read_b64 v[184:185], v40 offset:3840
  ds_read_b64 v[186:187], v40 offset:3848
  ds_read_b64 v[188:189], v40 offset:3968
  ds_read_b64 v[190:191], v40 offset:3976
  v_mov_b32 v16, 0
  v_mov_b32 v17, 0
  v_mov_b32 v18, 0
  v_mov_b32 v19, 0
  v_mov_b32 v20, 0
  v_mov_b32 v21, 0
  v_mov_b32 v22, 0
  v_mov_b32 v23, 0
  v_mov_b32 v24, 0
  v_mov_b32 v25, 0
  v_mov_b32 v26, 0
  v_mov_b32 v27, 0
  v_mov_b32 v28, 0
  v_mov_b32 v29, 0
  v_mov_b32 v30, 0
  v_mov_b32 v31, 0
  s_lshl_b32 s6, s88, 6
  v_add_u32 v44, s6, v1
  v_lshlrev_b32 v44, 4, v44
  s_lshl_b32 s88, s2, 13
  s_lshl_b32 s89, s3, 10
  s_add_u32 s88, s88, s89
  s_and_b32 s6, s3, 3
  s_lshl_b32 s7, s58, 2
  s_add_u32 s78, s6, s7
  s_lshl_b32 s80, s78, 15
  s_lshr_b32 s79, s3, 2
  s_lshl_b32 s7, s79, 14
  s_add_u32 s80, s80, s7
  s_add_u32 s80, s80, 3145728
  s_lshl_b32 s6, s3, 5
  v_add_u32 v7, s6, v3
  v_lshlrev_b32 v7, 4, v7
  v_lshlrev_b32 v63, 4, v0
  s_waitcnt vmcnt(3)
  v_lshlrev_b32 v246, 16, v246
  s_waitcnt vmcnt(2)
  v_lshlrev_b32 v247, 16, v247
  v_mul_f32 v216, 0xbfb8aa3b, v246
  v_mul_f32 v217, 0xbfb8aa3b, v247
  v_exp_f32 v216, v216
  v_exp_f32 v217, v217
  v_add_f32 v216, 1.0, v216
  v_add_f32 v217, 1.0, v217
  v_rcp_f32 v216, v216
  v_rcp_f32 v217, v217
  v_mul_f32 v246, v216, v246
  v_mul_f32 v247, v217, v247
  v_cvt_pk_bf16_f32 v5, v246, v247
  v_lshlrev_b32 v246, 16, v5
  v_and_b32 v247, 0xffff0000, v5
  s_waitcnt vmcnt(1)
  v_lshlrev_b32 v224, 16, v248
  v_and_b32 v225, 0xffff0000, v248
  v_lshlrev_b32 v226, 16, v249
  v_and_b32 v227, 0xffff0000, v249
  v_lshlrev_b32 v228, 16, v250
  v_and_b32 v229, 0xffff0000, v250
  v_lshlrev_b32 v230, 16, v251
  v_and_b32 v231, 0xffff0000, v251
  v_mul_f32 v216, v224, v246
  v_mul_f32 v217, v225, v246
  v_mul_f32 v218, v226, v246
  v_mul_f32 v219, v227, v246
  v_mul_f32 v220, v228, v246
  v_mul_f32 v221, v229, v246
  v_mul_f32 v222, v230, v246
  v_mul_f32 v223, v231, v246
  s_waitcnt vmcnt(0)
  v_lshlrev_b32 v224, 16, v252
  v_and_b32 v225, 0xffff0000, v252
  v_lshlrev_b32 v226, 16, v253
  v_and_b32 v227, 0xffff0000, v253
  v_lshlrev_b32 v228, 16, v254
  v_and_b32 v229, 0xffff0000, v254
  v_lshlrev_b32 v230, 16, v255
  v_and_b32 v231, 0xffff0000, v255
  v_fmac_f32 v216, v224, v247
  v_fmac_f32 v217, v225, v247
  v_fmac_f32 v218, v226, v247
  v_fmac_f32 v219, v227, v247
  v_fmac_f32 v220, v228, v247
  v_fmac_f32 v221, v229, v247
  v_fmac_f32 v222, v230, v247
  v_fmac_f32 v223, v231, v247
  v_permlane32_swap_b32 v216, v220
  v_permlane32_swap_b32 v217, v221
  v_permlane32_swap_b32 v218, v222
  v_permlane32_swap_b32 v219, v223
  v_add_f32 v216, v216, v220
  v_add_f32 v217, v217, v221
  v_add_f32 v218, v218, v222
  v_add_f32 v219, v219, v223
  s_nop 0
  v_permlane16_swap_b32 v216, v218
  v_permlane16_swap_b32 v217, v219
  v_add_f32 v216, v216, v218
  v_add_f32 v217, v217, v219
  s_nop 0
  v_add_f32_dpp v220, v216, v216 row_ror:8 row_mask:0xf bank_mask:0xf
  v_add_f32_dpp v221, v217, v217 row_ror:8 row_mask:0xf bank_mask:0xf
  v_and_b32 v6, 7, v1
  v_lshlrev_b32 v6, 5, v6
  v_lshrrev_b32 v5, 4, v1
  v_lshl_add_u32 v6, v5, 3, v6
  s_lshl_b32 s6, s3, 8
  v_add_u32 v6, s6, v6
  ds_write_b64 v6, v[220:221] offset:51968
  s_waitcnt lgkmcnt(0)
  s_mov_b32 s5, 2359296
  s_mov_b32 s6, 0
  s_cmp_lg_u32 s3, 2
  s_cbranch_scc1 L_polld0
L_poll0:
  buffer_load_dword v6, v44, s[8:11], s5 offen sc1
  s_add_u32 s6, s6, 1
  s_waitcnt vmcnt(0)
  v_cmp_ne_u32 vcc, s56, v6
  s_cbranch_vccz L_polld0
  s_sleep 1
  s_cmp_lt_u32 s6, 0x40000
  s_cbranch_scc1 L_poll0
L_polld0:
  s_barrier
  s_add_u32 m0, s89, 1280
  s_nop 0
  buffer_load_dwordx4 v2, s[8:11], s88 offen sc1 lds
  v_lshlrev_b32 v6, 2, v1
  ds_read_b32 v216, v6 offset:51968
  ds_read_b32 v217, v6 offset:52224
  ds_read_b32 v218, v6 offset:52480
  ds_read_b32 v219, v6 offset:52736
  ds_read_b32 v220, v6 offset:52992
  ds_read_b32 v221, v6 offset:53248
  ds_read_b32 v222, v6 offset:53504
  ds_read_b32 v223, v6 offset:53760
  s_waitcnt lgkmcnt(6)
  v_add_f32 v216, v216, v217
  s_waitcnt lgkmcnt(5)
  v_add_f32 v216, v216, v218
  s_waitcnt lgkmcnt(4)
  v_add_f32 v216, v216, v219
  s_waitcnt lgkmcnt(3)
  v_add_f32 v216, v216, v220
  s_waitcnt lgkmcnt(2)
  v_add_f32 v216, v216, v221
  s_waitcnt lgkmcnt(1)
  v_add_f32 v216, v216, v222
  s_waitcnt lgkmcnt(0)
  v_add_f32 v216, v216, v223
  buffer_store_dword v216, v2, s[8:11], s92 offen sc1
  s_waitcnt vmcnt(1)
  s_barrier
  s_cmp_lg_u32 s69, 0
  s_cbranch_scc1 L_v1
  ds_read_b128 v[32:35], v61 offset:0
  ds_read_b128 v[36:39], v60 offset:512
  ds_read_b128 v[40:43], v61 offset:512
  ds_read_b128 v[44:47], v60 offset:1024
  ds_read_b128 v[48:51], v61 offset:1024
  ds_read_b128 v[52:55], v60 offset:1536
  ds_read_b128 v[192:195], v61 offset:1536
  ds_read_b128 v[196:199], v60 offset:2048
  ds_read_b128 v[200:203], v61 offset:2048
  ds_read_b128 v[204:207], v60 offset:2560
  ds_read_b128 v[208:211], v61 offset:2560
  s_waitcnt lgkmcnt(10)
  v_mfma_f32_16x16x32_bf16 v[16:19], v[76:79], v[32:35], v[16:19]
  v_mfma_f32_16x16x32_bf16 v[20:23], v[124:127], v[32:35], v[20:23]
  v_mfma_f32_16x16x32_bf16 v[24:27], v[140:143], v[32:35], v[24:27]
  v_mfma_f32_16x16x32_bf16 v[28:31], v[188:191], v[32:35], v[28:31]
  ds_read_b128 v[224:227], v60 offset:3072
  s_add_u32 m0, s95, 98304
  s_add_u32 s6, s71, 0
  buffer_load_dwordx4 v244, s[48:51], s6 offen lds
  s_waitcnt lgkmcnt(10)
  v_mfma_f32_16x16x32_bf16 v[16:19], v[72:75], v[36:39], v[16:19]
  v_mfma_f32_16x16x32_bf16 v[20:23], v[120:123], v[36:39], v[20:23]
  v_mfma_f32_16x16x32_bf16 v[24:27], v[136:139], v[36:39], v[24:27]
  v_mfma_f32_16x16x32_bf16 v[28:31], v[184:187], v[36:39], v[28:31]
  ds_read_b128 v[32:35], v61 offset:3072
  s_add_u32 m0, s95, 99328
  s_add_u32 s6, s71, 8192
  buffer_load_dwordx4 v245, s[48:51], s6 offen lds
  s_waitcnt lgkmcnt(10)
  v_mfma_f32_16x16x32_bf16 v[16:19], v[68:71], v[40:43], v[16:19]
  v_mfma_f32_16x16x32_bf16 v[20:23], v[116:119], v[40:43], v[20:23]
  v_mfma_f32_16x16x32_bf16 v[24:27], v[132:135], v[40:43], v[24:27]
  v_mfma_f32_16x16x32_bf16 v[28:31], v[180:183], v[40:43], v[28:31]
  ds_read_b128 v[36:39], v60 offset:3584
  s_add_u32 m0, s95, 100352
  s_add_u32 s6, s71, 16384
  buffer_load_dwordx4 v244, s[48:51], s6 offen lds
  s_waitcnt lgkmcnt(10)
  v_mfma_f32_16x16x32_bf16 v[16:19], v[64:67], v[44:47], v[16:19]
  v_mfma_f32_16x16x32_bf16 v[16:19], v[56:59], v[44:47], v[16:19]
  v_mfma_f32_16x16x32_bf16 v[20:23], v[112:115], v[44:47], v[20:23]
  v_mfma_f32_16x16x32_bf16 v[24:27], v[128:131], v[44:47], v[24:27]
  v_mfma_f32_16x16x32_bf16 v[28:31], v[176:179], v[44:47], v[28:31]
  ds_read_b128 v[40:43], v61 offset:3584
  s_add_u32 m0, s95, 101376
  s_add_u32 s6, s71, 24576
  buffer_load_dwordx4 v245, s[48:51], s6 offen lds
  s_waitcnt lgkmcnt(10)
  v_mfma_f32_16x16x32_bf16 v[20:23], v[108:111], v[48:51], v[20:23]
  v_mfma_f32_16x16x32_bf16 v[24:27], v[124:127], v[48:51], v[24:27]
  v_mfma_f32_16x16x32_bf16 v[28:31], v[172:175], v[48:51], v[28:31]
  ds_read_b128 v[44:47], v60 offset:4096
  v_lshrrev_b32 v5, 3, v1
  v_mul_lo_u32 v5, v5, s93
  v_and_b32 v6, 7, v1
  v_lshl_add_u32 v5, v6, 4, v5
  s_mov_b32 m0, s72
  s_lshl_b32 s4, s93, 3
  s_add_u32 s4, s4, s94
  s_sub_u32 s4, s4, 1024
  buffer_load_dwordx4 v5, s[44:47], s94 offen lds
  buffer_load_dwordx4 v5, s[44:47], s4 offen offset:1024 lds
  s_waitcnt lgkmcnt(10)
  v_mfma_f32_16x16x32_bf16 v[20:23], v[104:107], v[52:55], v[20:23]
  v_mfma_f32_16x16x32_bf16 v[24:27], v[120:123], v[52:55], v[24:27]
  v_mfma_f32_16x16x32_bf16 v[28:31], v[168:171], v[52:55], v[28:31]
  ds_read_b128 v[48:51], v61 offset:4096
  s_waitcnt vmcnt(6)
  s_lshl_b32 s4, s61, 4
  s_add_u32 s4, s4, 2363392
  s_cmp_lg_u32 s3, 0
  s_cselect_b32 s4, 2146435072, s4
  v_mov_b32 v5, s56
  v_mov_b32 v254, s56
  v_mov_b32 v255, s62
  buffer_store_dwordx2 v[254:255], v14, s[8:11], s4 offen sc1
  s_waitcnt lgkmcnt(10)
  v_mfma_f32_16x16x32_bf16 v[20:23], v[100:103], v[192:195], v[20:23]
  v_mfma_f32_16x16x32_bf16 v[24:27], v[116:119], v[192:195], v[24:27]
  v_mfma_f32_16x16x32_bf16 v[28:31], v[164:167], v[192:195], v[28:31]
  ds_read_b128 v[52:55], v60 offset:4608
  s_waitcnt lgkmcnt(10)
  v_mfma_f32_16x16x32_bf16 v[20:23], v[96:99], v[196:199], v[20:23]
  v_mfma_f32_16x16x32_bf16 v[24:27], v[112:115], v[196:199], v[24:27]
  v_mfma_f32_16x16x32_bf16 v[28:31], v[160:163], v[196:199], v[28:31]
  ds_read_b128 v[192:195], v61 offset:4608
  s_waitcnt lgkmcnt(10)
  v_mfma_f32_16x16x32_bf16 v[20:23], v[92:95], v[200:203], v[20:23]
  v_mfma_f32_16x16x32_bf16 v[24:27], v[108:111], v[200:203], v[24:27]
  v_mfma_f32_16x16x32_bf16 v[28:31], v[156:159], v[200:203], v[28:31]
  ds_read_b128 v[196:199], v60 offset:5120
  s_waitcnt lgkmcnt(10)
  v_mfma_f32_16x16x32_bf16 v[20:23], v[88:91], v[204:207], v[20:23]
  v_mfma_f32_16x16x32_bf16 v[24:27], v[104:107], v[204:207], v[24:27]
  v_mfma_f32_16x16x32_bf16 v[28:31], v[152:155], v[204:207], v[28:31]
  ds_read_b128 v[200:203], v61 offset:5120
  s_waitcnt lgkmcnt(10)
  v_mfma_f32_16x16x32_bf16 v[20:23], v[84:87], v[208:211], v[20:23]
  v_mfma_f32_16x16x32_bf16 v[24:27], v[100:103], v[208:211], v[24:27]
  v_mfma_f32_16x16x32_bf16 v[28:31], v[148:151], v[208:211], v[28:31]
  ds_read_b128 v[204:207], v60 offset:5632
  s_waitcnt lgkmcnt(10)
  v_mfma_f32_16x16x32_bf16 v[20:23], v[80:83], v[224:227], v[20:23]
  v_mfma_f32_16x16x32_bf16 v[24:27], v[96:99], v[224:227], v[24:27]
  v_mfma_f32_16x16x32_bf16 v[28:31], v[144:147], v[224:227], v[28:31]
  ds_read_b128 v[208:211], v61 offset:5632
  s_waitcnt lgkmcnt(10)
  v_mfma_f32_16x16x32_bf16 v[20:23], v[76:79], v[32:35], v[20:23]
  v_mfma_f32_16x16x32_bf16 v[24:27], v[92:95], v[32:35], v[24:27]
  v_mfma_f32_16x16x32_bf16 v[28:31], v[140:143], v[32:35], v[28:31]
  ds_read_b128 v[224:227], v60 offset:6144
  s_waitcnt lgkmcnt(10)
  v_mfma_f32_16x16x32_bf16 v[20:23], v[72:75], v[36:39], v[20:23]
  v_mfma_f32_16x16x32_bf16 v[24:27], v[88:91], v[36:39], v[24:27]
  v_mfma_f32_16x16x32_bf16 v[28:31], v[136:139], v[36:39], v[28:31]
  ds_read_b128 v[32:35], v61 offset:6144
  s_waitcnt lgkmcnt(10)
  v_mfma_f32_16x16x32_bf16 v[20:23], v[68:71], v[40:43], v[20:23]
  v_mfma_f32_16x16x32_bf16 v[24:27], v[84:87], v[40:43], v[24:27]
  v_mfma_f32_16x16x32_bf16 v[28:31], v[132:135], v[40:43], v[28:31]
  ds_read_b128 v[36:39], v60 offset:6656
  s_waitcnt lgkmcnt(10)
  v_mfma_f32_16x16x32_bf16 v[20:23], v[64:67], v[44:47], v[20:23]
  v_mfma_f32_16x16x32_bf16 v[20:23], v[56:59], v[44:47], v[20:23]
  v_mfma_f32_16x16x32_bf16 v[24:27], v[80:83], v[44:47], v[24:27]
  v_mfma_f32_16x16x32_bf16 v[28:31], v[128:131], v[44:47], v[28:31]
  ds_read_b128 v[40:43], v61 offset:6656
  s_waitcnt lgkmcnt(10)
  v_mfma_f32_16x16x32_bf16 v[24:27], v[76:79], v[48:51], v[24:27]
  v_mfma_f32_16x16x32_bf16 v[28:31], v[124:127], v[48:51], v[28:31]
  ds_read_b128 v[44:47], v60 offset:7168
  s_waitcnt lgkmcnt(10)
  v_mfma_f32_16x16x32_bf16 v[24:27], v[72:75], v[52:55], v[24:27]
  v_mfma_f32_16x16x32_bf16 v[28:31], v[120:123], v[52:55], v[28:31]
  ds_read_b128 v[48:51], v61 offset:7168
  s_waitcnt lgkmcnt(10)
  v_mfma_f32_16x16x32_bf16 v[24:27], v[68:71], v[192:195], v[24:27]
  v_mfma_f32_16x16x32_bf16 v[28:31], v[116:119], v[192:195], v[28:31]
  ds_read_b128 v[52:55], v60 offset:7680
  s_waitcnt lgkmcnt(10)
  v_mfma_f32_16x16x32_bf16 v[24:27], v[64:67], v[196:199], v[24:27]
  v_mfma_f32_16x16x32_bf16 v[24:27], v[56:59], v[196:199], v[24:27]
  v_mfma_f32_16x16x32_bf16 v[28:31], v[112:115], v[196:199], v[28:31]
  ds_read_b128 v[192:195], v61 offset:7680
  s_waitcnt lgkmcnt(10)
  v_mfma_f32_16x16x32_bf16 v[28:31], v[108:111], v[200:203], v[28:31]
  ds_read_b128 v[196:199], v60 offset:8192
  s_waitcnt lgkmcnt(10)
  v_mfma_f32_16x16x32_bf16 v[28:31], v[104:107], v[204:207], v[28:31]
  s_waitcnt lgkmcnt(9)
  v_mfma_f32_16x16x32_bf16 v[28:31], v[100:103], v[208:211], v[28:31]
  s_waitcnt lgkmcnt(8)
  v_mfma_f32_16x16x32_bf16 v[28:31], v[96:99], v[224:227], v[28:31]
  s_waitcnt lgkmcnt(7)
  v_mfma_f32_16x16x32_bf16 v[28:31], v[92:95], v[32:35], v[28:31]
  s_waitcnt lgkmcnt(6)
  v_mfma_f32_16x16x32_bf16 v[28:31], v[88:91], v[36:39], v[28:31]
  s_waitcnt lgkmcnt(5)
  v_mfma_f32_16x16x32_bf16 v[28:31], v[84:87], v[40:43], v[28:31]
  s_waitcnt lgkmcnt(4)
  v_mfma_f32_16x16x32_bf16 v[28:31], v[80:83], v[44:47], v[28:31]
  s_waitcnt lgkmcnt(3)
  v_mfma_f32_16x16x32_bf16 v[28:31], v[76:79], v[48:51], v[28:31]
  s_waitcnt lgkmcnt(2)
  v_mfma_f32_16x16x32_bf16 v[28:31], v[72:75], v[52:55], v[28:31]
  s_waitcnt lgkmcnt(1)
  v_mfma_f32_16x16x32_bf16 v[28:31], v[68:71], v[192:195], v[28:31]
  s_waitcnt lgkmcnt(0)
  v_mfma_f32_16x16x32_bf16 v[28:31], v[64:67], v[196:199], v[28:31]
  v_mfma_f32_16x16x32_bf16 v[28:31], v[56:59], v[196:199], v[28:31]
  s_lshl_b32 s6, s3, 11
  v_add_u32 v5, s6, v2
  ds_write_b128 v5, v[24:27] offset:9472
  s_nop 4
  ds_write_b128 v5, v[28:31] offset:10496
  s_waitcnt lgkmcnt(0)
  s_barrier
  v_xor_b32 v5, 2048, v5
  ds_read_b128 v[32:35], v5 offset:9472
  ds_read_b128 v[36:39], v5 offset:10496
  s_waitcnt lgkmcnt(1)
  v_add_f32 v16, v16, v32
  v_add_f32 v17, v17, v33
  v_add_f32 v18, v18, v34
  v_add_f32 v19, v19, v35
  v_cvt_pk_bf16_f32 v48, v16, v17
  v_cvt_pk_bf16_f32 v49, v18, v19
  ds_write_b64 v62, v[48:49] offset:25856
  s_waitcnt lgkmcnt(1)
  v_add_f32 v20, v20, v36
  v_add_f32 v21, v21, v37
  v_add_f32 v22, v22, v38
  v_add_f32 v23, v23, v39
  v_cvt_pk_bf16_f32 v50, v20, v21
  v_cvt_pk_bf16_f32 v51, v22, v23
  ds_write_b64 v62, v[50:51] offset:29312
  s_waitcnt lgkmcnt(0)
  s_branch L_vjoin
L_v1:
  s_cmp_lg_u32 s69, 1
  s_cbranch_scc1 L_v2
  ds_read_b128 v[32:35], v60 offset:0
  ds_read_b128 v[36:39], v61 offset:0
  ds_read_b128 v[40:43], v60 offset:512
  ds_read_b128 v[44:47], v61 offset:512
  ds_read_b128 v[48:51], v60 offset:1024
  ds_read_b128 v[52:55], v61 offset:1024
  ds_read_b128 v[192:195], v60 offset:1536
  ds_read_b128 v[196:199], v61 offset:1536
  ds_read_b128 v[200:203], v60 offset:2048
  ds_read_b128 v[204:207], v61 offset:2048
  ds_read_b128 v[208:211], v60 offset:2560
  s_waitcnt lgkmcnt(10)
  v_mfma_f32_16x16x32_bf16 v[16:19], v[76:79], v[32:35], v[16:19]
  v_mfma_f32_16x16x32_bf16 v[20:23], v[124:127], v[32:35], v[20:23]
  v_mfma_f32_16x16x32_bf16 v[24:27], v[140:143], v[32:35], v[24:27]
  v_mfma_f32_16x16x32_bf16 v[28:31], v[188:191], v[32:35], v[28:31]
  ds_read_b128 v[224:227], v61 offset:2560
  s_add_u32 m0, s95, 98304
  s_add_u32 s6, s71, 0
  buffer_load_dwordx4 v244, s[48:51], s6 offen lds
  s_waitcnt lgkmcnt(10)
  v_mfma_f32_16x16x32_bf16 v[16:19], v[72:75], v[36:39], v[16:19]
  v_mfma_f32_16x16x32_bf16 v[20:23], v[120:123], v[36:39], v[20:23]
  v_mfma_f32_16x16x32_bf16 v[24:27], v[136:139], v[36:39], v[24:27]
  v_mfma_f32_16x16x32_bf16 v[28:31], v[184:187], v[36:39], v[28:31]
  ds_read_b128 v[32:35], v60 offset:3072
  s_add_u32 m0, s95, 99328
  s_add_u32 s6, s71, 8192
  buffer_load_dwordx4 v245, s[48:51], s6 offen lds
  s_waitcnt lgkmcnt(10)
  v_mfma_f32_16x16x32_bf16 v[16:19], v[68:71], v[40:43], v[16:19]
  v_mfma_f32_16x16x32_bf16 v[20:23], v[116:119], v[40:43], v[20:23]
  v_mfma_f32_16x16x32_bf16 v[24:27], v[132:135], v[40:43], v[24:27]
  v_mfma_f32_16x16x32_bf16 v[28:31], v[180:183], v[40:43], v[28:31]
  ds_read_b128 v[36:39], v61 offset:3072
  s_add_u32 m0, s95, 100352
  s_add_u32 s6, s71, 16384
  buffer_load_dwordx4 v244, s[48:51], s6 offen lds
  s_waitcnt lgkmcnt(10)
  v_mfma_f32_16x16x32_bf16 v[16:19], v[64:67], v[44:47], v[16:19]
  v_mfma_f32_16x16x32_bf16 v[20:23], v[112:115], v[44:47], v[20:23]
  v_mfma_f32_16x16x32_bf16 v[24:27], v[128:131], v[44:47], v[24:27]
  v_mfma_f32_16x16x32_bf16 v[28:31], v[176:179], v[44:47], v[28:31]
  ds_read_b128 v[40:43], v60 offset:3584
  s_add_u32 m0, s95, 101376
  s_add_u32 s6, s71, 24576
  buffer_load_dwordx4 v245, s[48:51], s6 offen lds
  s_waitcnt lgkmcnt(10)
  v_mfma_f32_16x16x32_bf16 v[20:23], v[108:111], v[48:51], v[20:23]
  v_mfma_f32_16x16x32_bf16 v[24:27], v[124:127], v[48:51], v[24:27]
  v_mfma_f32_16x16x32_bf16 v[28:31], v[172:175], v[48:51], v[28:31]
  ds_read_b128 v[44:47], v61 offset:3584
  v_lshrrev_b32 v5, 3, v1
  v_mul_lo_u32 v5, v5, s93
  v_and_b32 v6, 7, v1
  v_lshl_add_u32 v5, v6, 4, v5
  s_mov_b32 m0, s72
  s_lshl_b32 s4, s93, 3
  s_add_u32 s4, s4, s94
  s_sub_u32 s4, s4, 1024
  buffer_load_dwordx4 v5, s[44:47], s94 offen lds
  buffer_load_dwordx4 v5, s[44:47], s4 offen offset:1024 lds
  s_waitcnt lgkmcnt(10)
  v_mfma_f32_16x16x32_bf16 v[20:23], v[104:107], v[52:55], v[20:23]
  v_mfma_f32_16x16x32_bf16 v[24:27], v[120:123], v[52:55], v[24:27]
  v_mfma_f32_16x16x32_bf16 v[28:31], v[168:171], v[52:55], v[28:31]
  ds_read_b128 v[48:51], v60 offset:4096
  s_waitcnt vmcnt(6)
  s_lshl_b32 s4, s61, 4
  s_add_u32 s4, s4, 2363392
  s_cmp_lg_u32 s3, 0
  s_cselect_b32 s4, 2146435072, s4
  v_mov_b32 v5, s56
  v_mov_b32 v254, s56
  v_mov_b32 v255, s62
  buffer_store_dwordx2 v[254:255], v14, s[8:11], s4 offen sc1
  s_waitcnt lgkmcnt(10)
  v_mfma_f32_16x16x32_bf16 v[20:23], v[100:103], v[192:195], v[20:23]
  v_mfma_f32_16x16x32_bf16 v[24:27], v[116:119], v[192:195], v[24:27]
  v_mfma_f32_16x16x32_bf16 v[28:31], v[164:167], v[192:195], v[28:31]
  ds_read_b128 v[52:55], v61 offset:4096
  s_waitcnt lgkmcnt(10)
  v_mfma_f32_16x16x32_bf16 v[20:23], v[96:99], v[196:199], v[20:23]
  v_mfma_f32_16x16x32_bf16 v[24:27], v[112:115], v[196:199], v[24:27]
  v_mfma_f32_16x16x32_bf16 v[28:31], v[160:163], v[196:199], v[28:31]
  ds_read_b128 v[192:195], v60 offset:4608
  s_waitcnt lgkmcnt(10)
  v_mfma_f32_16x16x32_bf16 v[20:23], v[92:95], v[200:203], v[20:23]
  v_mfma_f32_16x16x32_bf16 v[24:27], v[108:111], v[200:203], v[24:27]
  v_mfma_f32_16x16x32_bf16 v[28:31], v[156:159], v[200:203], v[28:31]
  ds_read_b128 v[196:199], v61 offset:4608
  s_waitcnt lgkmcnt(10)
  v_mfma_f32_16x16x32_bf16 v[20:23], v[88:91], v[204:207], v[20:23]
  v_mfma_f32_16x16x32_bf16 v[24:27], v[104:107], v[204:207], v[24:27]
  v_mfma_f32_16x16x32_bf16 v[28:31], v[152:155], v[204:207], v[28:31]
  ds_read_b128 v[200:203], v60 offset:5120
  s_waitcnt lgkmcnt(10)
  v_mfma_f32_16x16x32_bf16 v[20:23], v[84:87], v[208:211], v[20:23]
  v_mfma_f32_16x16x32_bf16 v[24:27], v[100:103], v[208:211], v[24:27]
  v_mfma_f32_16x16x32_bf16 v[28:31], v[148:151], v[208:211], v[28:31]
  ds_read_b128 v[204:207], v61 offset:5120
  s_waitcnt lgkmcnt(10)
  v_mfma_f32_16x16x32_bf16 v[20:23], v[80:83], v[224:227], v[20:23]
  v_mfma_f32_16x16x32_bf16 v[24:27], v[96:99], v[224:227], v[24:27]
  v_mfma_f32_16x16x32_bf16 v[28:31], v[144:147], v[224:227], v[28:31]
  ds_read_b128 v[208:211], v60 offset:5632
  s_waitcnt lgkmcnt(10)
  v_mfma_f32_16x16x32_bf16 v[20:23], v[76:79], v[32:35], v[20:23]
  v_mfma_f32_16x16x32_bf16 v[24:27], v[92:95], v[32:35], v[24:27]
  v_mfma_f32_16x16x32_bf16 v[28:31], v[140:143], v[32:35], v[28:31]
  ds_read_b128 v[224:227], v61 offset:5632
  s_waitcnt lgkmcnt(10)
  v_mfma_f32_16x16x32_bf16 v[20:23], v[72:75], v[36:39], v[20:23]
  v_mfma_f32_16x16x32_bf16 v[24:27], v[88:91], v[36:39], v[24:27]
  v_mfma_f32_16x16x32_bf16 v[28:31], v[136:139], v[36:39], v[28:31]
  ds_read_b128 v[32:35], v60 offset:6144
  s_waitcnt lgkmcnt(10)
  v_mfma_f32_16x16x32_bf16 v[20:23], v[68:71], v[40:43], v[20:23]
  v_mfma_f32_16x16x32_bf16 v[24:27], v[84:87], v[40:43], v[24:27]
  v_mfma_f32_16x16x32_bf16 v[28:31], v[132:135], v[40:43], v[28:31]
  ds_read_b128 v[36:39], v61 offset:6144
  s_waitcnt lgkmcnt(10)
  v_mfma_f32_16x16x32_bf16 v[20:23], v[64:67], v[44:47], v[20:23]
  v_mfma_f32_16x16x32_bf16 v[24:27], v[80:83], v[44:47], v[24:27]
  v_mfma_f32_16x16x32_bf16 v[28:31], v[128:131], v[44:47], v[28:31]
  ds_read_b128 v[40:43], v60 offset:6656
  s_waitcnt lgkmcnt(10)
  v_mfma_f32_16x16x32_bf16 v[24:27], v[76:79], v[48:51], v[24:27]
  v_mfma_f32_16x16x32_bf16 v[28:31], v[124:127], v[48:51], v[28:31]
  ds_read_b128 v[44:47], v61 offset:6656
  s_waitcnt lgkmcnt(10)
  v_mfma_f32_16x16x32_bf16 v[24:27], v[72:75], v[52:55], v[24:27]
  v_mfma_f32_16x16x32_bf16 v[28:31], v[120:123], v[52:55], v[28:31]
  ds_read_b128 v[48:51], v60 offset:7168
  s_waitcnt lgkmcnt(10)
  v_mfma_f32_16x16x32_bf16 v[24:27], v[68:71], v[192:195], v[24:27]
  v_mfma_f32_16x16x32_bf16 v[28:31], v[116:119], v[192:195], v[28:31]
  ds_read_b128 v[52:55], v61 offset:7168
  s_waitcnt lgkmcnt(10)
  v_mfma_f32_16x16x32_bf16 v[24:27], v[64:67], v[196:199], v[24:27]
  v_mfma_f32_16x16x32_bf16 v[28:31], v[112:115], v[196:199], v[28:31]
  ds_read_b128 v[192:195], v60 offset:7680
  s_waitcnt lgkmcnt(10)
  v_mfma_f32_16x16x32_bf16 v[28:31], v[108:111], v[200:203], v[28:31]
  ds_read_b128 v[196:199], v61 offset:7680
  s_waitcnt lgkmcnt(10)
  v_mfma_f32_16x16x32_bf16 v[28:31], v[104:107], v[204:207], v[28:31]
  s_waitcnt lgkmcnt(9)
  v_mfma_f32_16x16x32_bf16 v[28:31], v[100:103], v[208:211], v[28:31]
  s_waitcnt lgkmcnt(8)
  v_mfma_f32_16x16x32_bf16 v[28:31], v[96:99], v[224:227], v[28:31]
  s_waitcnt lgkmcnt(7)
  v_mfma_f32_16x16x32_bf16 v[28:31], v[92:95], v[32:35], v[28:31]
  s_waitcnt lgkmcnt(6)
  v_mfma_f32_16x16x32_bf16 v[28:31], v[88:91], v[36:39], v[28:31]
  s_waitcnt lgkmcnt(5)
  v_mfma_f32_16x16x32_bf16 v[28:31], v[84:87], v[40:43], v[28:31]
  s_waitcnt lgkmcnt(4)
  v_mfma_f32_16x16x32_bf16 v[28:31], v[80:83], v[44:47], v[28:31]
  s_waitcnt lgkmcnt(3)
  v_mfma_f32_16x16x32_bf16 v[28:31], v[76:79], v[48:51], v[28:31]
  s_waitcnt lgkmcnt(2)
  v_mfma_f32_16x16x32_bf16 v[28:31], v[72:75], v[52:55], v[28:31]
  s_waitcnt lgkmcnt(1)
  v_mfma_f32_16x16x32_bf16 v[28:31], v[68:71], v[192:195], v[28:31]
  s_waitcnt lgkmcnt(0)
  v_mfma_f32_16x16x32_bf16 v[28:31], v[64:67], v[196:199], v[28:31]
  s_lshl_b32 s6, s3, 11
  v_add_u32 v5, s6, v2
  ds_write_b128 v5, v[16:19] offset:9472
  ds_write_b128 v5, v[20:23] offset:10496
  s_waitcnt lgkmcnt(0)
  s_barrier
  v_xor_b32 v5, 2048, v5
  ds_read_b128 v[32:35], v5 offset:9472
  ds_read_b128 v[36:39], v5 offset:10496
  s_waitcnt lgkmcnt(1)
  v_add_f32 v24, v24, v32
  v_add_f32 v25, v25, v33
  v_add_f32 v26, v26, v34
  v_add_f32 v27, v27, v35
  v_cvt_pk_bf16_f32 v48, v24, v25
  v_cvt_pk_bf16_f32 v49, v26, v27
  ds_write_b64 v62, v[48:49] offset:30464
  s_waitcnt lgkmcnt(1)
  v_add_f32 v28, v28, v36
  v_add_f32 v29, v29, v37
  v_add_f32 v30, v30, v38
  v_add_f32 v31, v31, v39
  v_cvt_pk_bf16_f32 v50, v28, v29
  v_cvt_pk_bf16_f32 v51, v30, v31
  ds_write_b64 v62, v[50:51] offset:33920
  s_waitcnt lgkmcnt(0)
  s_branch L_vjoin
L_v2:
  s_cmp_lg_u32 s69, 2
  s_cbranch_scc1 L_v3
  ds_read_b128 v[32:35], v61 offset:0
  ds_read_b128 v[36:39], v60 offset:512
  ds_read_b128 v[40:43], v61 offset:512
  ds_read_b128 v[44:47], v60 offset:1024
  ds_read_b128 v[48:51], v61 offset:1024
  ds_read_b128 v[52:55], v60 offset:1536
  ds_read_b128 v[192:195], v61 offset:1536
  ds_read_b128 v[196:199], v60 offset:2048
  ds_read_b128 v[200:203], v61 offset:2048
  ds_read_b128 v[204:207], v60 offset:2560
  ds_read_b128 v[208:211], v61 offset:2560
  s_waitcnt lgkmcnt(10)
  v_mfma_f32_16x16x32_bf16 v[16:19], v[92:95], v[32:35], v[16:19]
  v_mfma_f32_16x16x32_bf16 v[20:23], v[108:111], v[32:35], v[20:23]
  v_mfma_f32_16x16x32_bf16 v[24:27], v[156:159], v[32:35], v[24:27]
  v_mfma_f32_16x16x32_bf16 v[28:31], v[172:175], v[32:35], v[28:31]
  ds_read_b128 v[224:227], v60 offset:3072
  s_add_u32 m0, s95, 98304
  s_add_u32 s6, s71, 0
  buffer_load_dwordx4 v244, s[48:51], s6 offen lds
  s_waitcnt lgkmcnt(10)
  v_mfma_f32_16x16x32_bf16 v[16:19], v[88:91], v[36:39], v[16:19]
  v_mfma_f32_16x16x32_bf16 v[20:23], v[104:107], v[36:39], v[20:23]
  v_mfma_f32_16x16x32_bf16 v[24:27], v[152:155], v[36:39], v[24:27]
  v_mfma_f32_16x16x32_bf16 v[28:31], v[168:171], v[36:39], v[28:31]
  ds_read_b128 v[32:35], v61 offset:3072
  s_add_u32 m0, s95, 99328
  s_add_u32 s6, s71, 8192
  buffer_load_dwordx4 v245, s[48:51], s6 offen lds
  s_waitcnt lgkmcnt(10)
  v_mfma_f32_16x16x32_bf16 v[16:19], v[84:87], v[40:43], v[16:19]
  v_mfma_f32_16x16x32_bf16 v[20:23], v[100:103], v[40:43], v[20:23]
  v_mfma_f32_16x16x32_bf16 v[24:27], v[148:151], v[40:43], v[24:27]
  v_mfma_f32_16x16x32_bf16 v[28:31], v[164:167], v[40:43], v[28:31]
  ds_read_b128 v[36:39], v60 offset:3584
  s_add_u32 m0, s95, 100352
  s_add_u32 s6, s71, 16384
  buffer_load_dwordx4 v244, s[48:51], s6 offen lds
  s_waitcnt lgkmcnt(10)
  v_mfma_f32_16x16x32_bf16 v[16:19], v[80:83], v[44:47], v[16:19]
  v_mfma_f32_16x16x32_bf16 v[20:23], v[96:99], v[44:47], v[20:23]
  v_mfma_f32_16x16x32_bf16 v[24:27], v[144:147], v[44:47], v[24:27]
  v_mfma_f32_16x16x32_bf16 v[28:31], v[160:163], v[44:47], v[28:31]
  ds_read_b128 v[40:43], v61 offset:3584
  s_add_u32 m0, s95, 101376
  s_add_u32 s6, s71, 24576
  buffer_load_dwordx4 v245, s[48:51], s6 offen lds
  s_waitcnt lgkmcnt(10)
  v_mfma_f32_16x16x32_bf16 v[16:19], v[76:79], v[48:51], v[16:19]
  v_mfma_f32_16x16x32_bf16 v[20:23], v[92:95], v[48:51], v[20:23]
  v_mfma_f32_16x16x32_bf16 v[24:27], v[140:143], v[48:51], v[24:27]
  v_mfma_f32_16x16x32_bf16 v[28:31], v[156:159], v[48:51], v[28:31]
  ds_read_b128 v[44:47], v60 offset:4096
  v_lshrrev_b32 v5, 3, v1
  v_mul_lo_u32 v5, v5, s93
  v_and_b32 v6, 7, v1
  v_lshl_add_u32 v5, v6, 4, v5
  s_mov_b32 m0, s72
  s_lshl_b32 s4, s93, 3
  s_add_u32 s4, s4, s94
  s_sub_u32 s4, s4, 1024
  buffer_load_dwordx4 v5, s[44:47], s94 offen lds
  buffer_load_dwordx4 v5, s[44:47], s4 offen offset:1024 lds
  s_waitcnt lgkmcnt(10)
  v_mfma_f32_16x16x32_bf16 v[16:19], v[72:75], v[52:55], v[16:19]
  v_mfma_f32_16x16x32_bf16 v[20:23], v[88:91], v[52:55], v[20:23]
  v_mfma_f32_16x16x32_bf16 v[24:27], v[136:139], v[52:55], v[24:27]
  v_mfma_f32_16x16x32_bf16 v[28:31], v[152:155], v[52:55], v[28:31]
  ds_read_b128 v[48:51], v61 offset:4096
  s_waitcnt vmcnt(6)
  s_lshl_b32 s4, s61, 4
  s_add_u32 s4, s4, 2363392
  s_cmp_lg_u32 s3, 0
  s_cselect_b32 s4, 2146435072, s4
  v_mov_b32 v5, s56
  v_mov_b32 v254, s56
  v_mov_b32 v255, s62
  buffer_store_dwordx2 v[254:255], v14, s[8:11], s4 offen sc1
  s_waitcnt lgkmcnt(10)
  v_mfma_f32_16x16x32_bf16 v[16:19], v[68:71], v[192:195], v[16:19]
  v_mfma_f32_16x16x32_bf16 v[20:23], v[84:87], v[192:195], v[20:23]
  v_mfma_f32_16x16x32_bf16 v[24:27], v[132:135], v[192:195], v[24:27]
  v_mfma_f32_16x16x32_bf16 v[28:31], v[148:151], v[192:195], v[28:31]
  ds_read_b128 v[52:55], v60 offset:4608
  s_waitcnt lgkmcnt(10)
  v_mfma_f32_16x16x32_bf16 v[16:19], v[64:67], v[196:199], v[16:19]
  v_mfma_f32_16x16x32_bf16 v[16:19], v[56:59], v[196:199], v[16:19]
  v_mfma_f32_16x16x32_bf16 v[20:23], v[80:83], v[196:199], v[20:23]
  v_mfma_f32_16x16x32_bf16 v[24:27], v[128:131], v[196:199], v[24:27]
  v_mfma_f32_16x16x32_bf16 v[28:31], v[144:147], v[196:199], v[28:31]
  ds_read_b128 v[192:195], v61 offset:4608
  s_waitcnt lgkmcnt(10)
  v_mfma_f32_16x16x32_bf16 v[20:23], v[76:79], v[200:203], v[20:23]
  v_mfma_f32_16x16x32_bf16 v[24:27], v[124:127], v[200:203], v[24:27]
  v_mfma_f32_16x16x32_bf16 v[28:31], v[140:143], v[200:203], v[28:31]
  ds_read_b128 v[196:199], v60 offset:5120
  s_waitcnt lgkmcnt(10)
  v_mfma_f32_16x16x32_bf16 v[20:23], v[72:75], v[204:207], v[20:23]
  v_mfma_f32_16x16x32_bf16 v[24:27], v[120:123], v[204:207], v[24:27]
  v_mfma_f32_16x16x32_bf16 v[28:31], v[136:139], v[204:207], v[28:31]
  ds_read_b128 v[200:203], v61 offset:5120
  s_waitcnt lgkmcnt(10)
  v_mfma_f32_16x16x32_bf16 v[20:23], v[68:71], v[208:211], v[20:23]
  v_mfma_f32_16x16x32_bf16 v[24:27], v[116:119], v[208:211], v[24:27]
  v_mfma_f32_16x16x32_bf16 v[28:31], v[132:135], v[208:211], v[28:31]
  ds_read_b128 v[204:207], v60 offset:5632
  s_waitcnt lgkmcnt(10)
  v_mfma_f32_16x16x32_bf16 v[20:23], v[64:67], v[224:227], v[20:23]
  v_mfma_f32_16x16x32_bf16 v[20:23], v[56:59], v[224:227], v[20:23]
  v_mfma_f32_16x16x32_bf16 v[24:27], v[112:115], v[224:227], v[24:27]
  v_mfma_f32_16x16x32_bf16 v[28:31], v[128:131], v[224:227], v[28:31]
  ds_read_b128 v[208:211], v61 offset:5632
  s_waitcnt lgkmcnt(10)
  v_mfma_f32_16x16x32_bf16 v[24:27], v[108:111], v[32:35], v[24:27]
  v_mfma_f32_16x16x32_bf16 v[28:31], v[124:127], v[32:35], v[28:31]
  ds_read_b128 v[224:227], v60 offset:6144
  s_waitcnt lgkmcnt(10)
  v_mfma_f32_16x16x32_bf16 v[24:27], v[104:107], v[36:39], v[24:27]
  v_mfma_f32_16x16x32_bf16 v[28:31], v[120:123], v[36:39], v[28:31]
  ds_read_b128 v[32:35], v61 offset:6144
  s_waitcnt lgkmcnt(10)
  v_mfma_f32_16x16x32_bf16 v[24:27], v[100:103], v[40:43], v[24:27]
  v_mfma_f32_16x16x32_bf16 v[28:31], v[116:119], v[40:43], v[28:31]
  ds_read_b128 v[36:39], v60 offset:6656
  s_waitcnt lgkmcnt(10)
  v_mfma_f32_16x16x32_bf16 v[24:27], v[96:99], v[44:47], v[24:27]
  v_mfma_f32_16x16x32_bf16 v[28:31], v[112:115], v[44:47], v[28:31]
  ds_read_b128 v[40:43], v61 offset:6656
  s_waitcnt lgkmcnt(10)
  v_mfma_f32_16x16x32_bf16 v[24:27], v[92:95], v[48:51], v[24:27]
  v_mfma_f32_16x16x32_bf16 v[28:31], v[108:111], v[48:51], v[28:31]
  ds_read_b128 v[44:47], v60 offset:7168
  s_waitcnt lgkmcnt(10)
  v_mfma_f32_16x16x32_bf16 v[24:27], v[88:91], v[52:55], v[24:27]
  v_mfma_f32_16x16x32_bf16 v[28:31], v[104:107], v[52:55], v[28:31]
  s_waitcnt lgkmcnt(9)
  v_mfma_f32_16x16x32_bf16 v[24:27], v[84:87], v[192:195], v[24:27]
  v_mfma_f32_16x16x32_bf16 v[28:31], v[100:103], v[192:195], v[28:31]
  s_waitcnt lgkmcnt(8)
  v_mfma_f32_16x16x32_bf16 v[24:27], v[80:83], v[196:199], v[24:27]
  v_mfma_f32_16x16x32_bf16 v[28:31], v[96:99], v[196:199], v[28:31]
  s_waitcnt lgkmcnt(7)
  v_mfma_f32_16x16x32_bf16 v[24:27], v[76:79], v[200:203], v[24:27]
  v_mfma_f32_16x16x32_bf16 v[28:31], v[92:95], v[200:203], v[28:31]
  s_waitcnt lgkmcnt(6)
  v_mfma_f32_16x16x32_bf16 v[24:27], v[72:75], v[204:207], v[24:27]
  v_mfma_f32_16x16x32_bf16 v[28:31], v[88:91], v[204:207], v[28:31]
  s_waitcnt lgkmcnt(5)
  v_mfma_f32_16x16x32_bf16 v[24:27], v[68:71], v[208:211], v[24:27]
  v_mfma_f32_16x16x32_bf16 v[28:31], v[84:87], v[208:211], v[28:31]
  s_waitcnt lgkmcnt(4)
  v_mfma_f32_16x16x32_bf16 v[24:27], v[64:67], v[224:227], v[24:27]
  v_mfma_f32_16x16x32_bf16 v[24:27], v[56:59], v[224:227], v[24:27]
  v_mfma_f32_16x16x32_bf16 v[28:31], v[80:83], v[224:227], v[28:31]
  s_waitcnt lgkmcnt(3)
  v_mfma_f32_16x16x32_bf16 v[28:31], v[76:79], v[32:35], v[28:31]
  s_waitcnt lgkmcnt(2)
  v_mfma_f32_16x16x32_bf16 v[28:31], v[72:75], v[36:39], v[28:31]
  s_waitcnt lgkmcnt(1)
  v_mfma_f32_16x16x32_bf16 v[28:31], v[68:71], v[40:43], v[28:31]
  s_waitcnt lgkmcnt(0)
  v_mfma_f32_16x16x32_bf16 v[28:31], v[64:67], v[44:47], v[28:31]
  v_mfma_f32_16x16x32_bf16 v[28:31], v[56:59], v[44:47], v[28:31]
  s_lshl_b32 s6, s3, 11
  v_add_u32 v5, s6, v2
  ds_write_b128 v5, v[24:27] offset:9472
  s_nop 4
  ds_write_b128 v5, v[28:31] offset:10496
  s_waitcnt lgkmcnt(0)
  s_barrier
  v_xor_b32 v5, 2048, v5
  ds_read_b128 v[32:35], v5 offset:9472
  ds_read_b128 v[36:39], v5 offset:10496
  s_waitcnt lgkmcnt(1)
  v_add_f32 v16, v16, v32
  v_add_f32 v17, v17, v33
  v_add_f32 v18, v18, v34
  v_add_f32 v19, v19, v35
  v_cvt_pk_bf16_f32 v48, v16, v17
  v_cvt_pk_bf16_f32 v49, v18, v19
  ds_write_b64 v62, v[48:49] offset:27008
  s_waitcnt lgkmcnt(1)
  v_add_f32 v20, v20, v36
  v_add_f32 v21, v21, v37
  v_add_f32 v22, v22, v38
  v_add_f32 v23, v23, v39
  v_cvt_pk_bf16_f32 v50, v20, v21
  v_cvt_pk_bf16_f32 v51, v22, v23
  ds_write_b64 v62, v[50:51] offset:28160
  s_waitcnt lgkmcnt(0)
  s_branch L_vjoin
L_v3:
  ds_read_b128 v[32:35], v60 offset:0
  ds_read_b128 v[36:39], v61 offset:0
  ds_read_b128 v[40:43], v60 offset:512
  ds_read_b128 v[44:47], v61 offset:512
  ds_read_b128 v[48:51], v60 offset:1024
  ds_read_b128 v[52:55], v61 offset:1024
  ds_read_b128 v[192:195], v60 offset:1536
  ds_read_b128 v[196:199], v61 offset:1536
  ds_read_b128 v[200:203], v60 offset:2048
  ds_read_b128 v[204:207], v61 offset:2048
  ds_read_b128 v[208:211], v60 offset:2560
  s_waitcnt lgkmcnt(10)
  v_mfma_f32_16x16x32_bf16 v[16:19], v[92:95], v[32:35], v[16:19]
  v_mfma_f32_16x16x32_bf16 v[20:23], v[108:111], v[32:35], v[20:23]
  v_mfma_f32_16x16x32_bf16 v[24:27], v[156:159], v[32:35], v[24:27]
  v_mfma_f32_16x16x32_bf16 v[28:31], v[172:175], v[32:35], v[28:31]
  ds_read_b128 v[224:227], v61 offset:2560
  s_add_u32 m0, s95, 98304
  s_add_u32 s6, s71, 0
  buffer_load_dwordx4 v244, s[48:51], s6 offen lds
  s_waitcnt lgkmcnt(10)
  v_mfma_f32_16x16x32_bf16 v[16:19], v[88:91], v[36:39], v[16:19]
  v_mfma_f32_16x16x32_bf16 v[20:23], v[104:107], v[36:39], v[20:23]
  v_mfma_f32_16x16x32_bf16 v[24:27], v[152:155], v[36:39], v[24:27]
  v_mfma_f32_16x16x32_bf16 v[28:31], v[168:171], v[36:39], v[28:31]
  ds_read_b128 v[32:35], v60 offset:3072
  s_add_u32 m0, s95, 99328
  s_add_u32 s6, s71, 8192
  buffer_load_dwordx4 v245, s[48:51], s6 offen lds
  s_waitcnt lgkmcnt(10)
  v_mfma_f32_16x16x32_bf16 v[16:19], v[84:87], v[40:43], v[16:19]
  v_mfma_f32_16x16x32_bf16 v[20:23], v[100:103], v[40:43], v[20:23]
  v_mfma_f32_16x16x32_bf16 v[24:27], v[148:151], v[40:43], v[24:27]
  v_mfma_f32_16x16x32_bf16 v[28:31], v[164:167], v[40:43], v[28:31]
  ds_read_b128 v[36:39], v61 offset:3072
  s_add_u32 m0, s95, 100352
  s_add_u32 s6, s71, 16384
  buffer_load_dwordx4 v244, s[48:51], s6 offen lds
  s_waitcnt lgkmcnt(10)
  v_mfma_f32_16x16x32_bf16 v[16:19], v[80:83], v[44:47], v[16:19]
  v_mfma_f32_16x16x32_bf16 v[20:23], v[96:99], v[44:47], v[20:23]
  v_mfma_f32_16x16x32_bf16 v[24:27], v[144:147], v[44:47], v[24:27]
  v_mfma_f32_16x16x32_bf16 v[28:31], v[160:163], v[44:47], v[28:31]
  ds_read_b128 v[40:43], v60 offset:3584
  s_add_u32 m0, s95, 101376
  s_add_u32 s6, s71, 24576
  buffer_load_dwordx4 v245, s[48:51], s6 offen lds
  s_waitcnt lgkmcnt(10)
  v_mfma_f32_16x16x32_bf16 v[16:19], v[76:79], v[48:51], v[16:19]
  v_mfma_f32_16x16x32_bf16 v[20:23], v[92:95], v[48:51], v[20:23]
  v_mfma_f32_16x16x32_bf16 v[24:27], v[140:143], v[48:51], v[24:27]
  v_mfma_f32_16x16x32_bf16 v[28:31], v[156:159], v[48:51], v[28:31]
  ds_read_b128 v[44:47], v61 offset:3584
  v_lshrrev_b32 v5, 3, v1
  v_mul_lo_u32 v5, v5, s93
  v_and_b32 v6, 7, v1
  v_lshl_add_u32 v5, v6, 4, v5
  s_mov_b32 m0, s72
  s_lshl_b32 s4, s93, 3
  s_add_u32 s4, s4, s94
  s_sub_u32 s4, s4, 1024
  buffer_load_dwordx4 v5, s[44:47], s94 offen lds
  buffer_load_dwordx4 v5, s[44:47], s4 offen offset:1024 lds
  s_waitcnt lgkmcnt(10)
  v_mfma_f32_16x16x32_bf16 v[16:19], v[72:75], v[52:55], v[16:19]
  v_mfma_f32_16x16x32_bf16 v[20:23], v[88:91], v[52:55], v[20:23]
  v_mfma_f32_16x16x32_bf16 v[24:27], v[136:139], v[52:55], v[24:27]
  v_mfma_f32_16x16x32_bf16 v[28:31], v[152:155], v[52:55], v[28:31]
  ds_read_b128 v[48:51], v60 offset:4096
  s_waitcnt vmcnt(6)
  s_lshl_b32 s4, s61, 4
  s_add_u32 s4, s4, 2363392
  s_cmp_lg_u32 s3, 0
  s_cselect_b32 s4, 2146435072, s4
  v_mov_b32 v5, s56
  v_mov_b32 v254, s56
  v_mov_b32 v255, s62
  buffer_store_dwordx2 v[254:255], v14, s[8:11], s4 offen sc1
  s_waitcnt lgkmcnt(10)
  v_mfma_f32_16x16x32_bf16 v[16:19], v[68:71], v[192:195], v[16:19]
  v_mfma_f32_16x16x32_bf16 v[20:23], v[84:87], v[192:195], v[20:23]
  v_mfma_f32_16x16x32_bf16 v[24:27], v[132:135], v[192:195], v[24:27]
  v_mfma_f32_16x16x32_bf16 v[28:31], v[148:151], v[192:195], v[28:31]
  ds_read_b128 v[52:55], v61 offset:4096
  s_waitcnt lgkmcnt(10)
  v_mfma_f32_16x16x32_bf16 v[16:19], v[64:67], v[196:199], v[16:19]
  v_mfma_f32_16x16x32_bf16 v[20:23], v[80:83], v[196:199], v[20:23]
  v_mfma_f32_16x16x32_bf16 v[24:27], v[128:131], v[196:199], v[24:27]
  v_mfma_f32_16x16x32_bf16 v[28:31], v[144:147], v[196:199], v[28:31]
  ds_read_b128 v[192:195], v60 offset:4608
  s_waitcnt lgkmcnt(10)
  v_mfma_f32_16x16x32_bf16 v[20:23], v[76:79], v[200:203], v[20:23]
  v_mfma_f32_16x16x32_bf16 v[24:27], v[124:127], v[200:203], v[24:27]
  v_mfma_f32_16x16x32_bf16 v[28:31], v[140:143], v[200:203], v[28:31]
  ds_read_b128 v[196:199], v61 offset:4608
  s_waitcnt lgkmcnt(10)
  v_mfma_f32_16x16x32_bf16 v[20:23], v[72:75], v[204:207], v[20:23]
  v_mfma_f32_16x16x32_bf16 v[24:27], v[120:123], v[204:207], v[24:27]
  v_mfma_f32_16x16x32_bf16 v[28:31], v[136:139], v[204:207], v[28:31]
  ds_read_b128 v[200:203], v60 offset:5120
  s_waitcnt lgkmcnt(10)
  v_mfma_f32_16x16x32_bf16 v[20:23], v[68:71], v[208:211], v[20:23]
  v_mfma_f32_16x16x32_bf16 v[24:27], v[116:119], v[208:211], v[24:27]
  v_mfma_f32_16x16x32_bf16 v[28:31], v[132:135], v[208:211], v[28:31]
  ds_read_b128 v[204:207], v61 offset:5120
  s_waitcnt lgkmcnt(10)
  v_mfma_f32_16x16x32_bf16 v[20:23], v[64:67], v[224:227], v[20:23]
  v_mfma_f32_16x16x32_bf16 v[24:27], v[112:115], v[224:227], v[24:27]
  v_mfma_f32_16x16x32_bf16 v[28:31], v[128:131], v[224:227], v[28:31]
  ds_read_b128 v[208:211], v60 offset:5632
  s_waitcnt lgkmcnt(10)
  v_mfma_f32_16x16x32_bf16 v[24:27], v[108:111], v[32:35], v[24:27]
  v_mfma_f32_16x16x32_bf16 v[28:31], v[124:127], v[32:35], v[28:31]
  ds_read_b128 v[224:227], v61 offset:5632
  s_waitcnt lgkmcnt(10)
  v_mfma_f32_16x16x32_bf16 v[24:27], v[104:107], v[36:39], v[24:27]
  v_mfma_f32_16x16x32_bf16 v[28:31], v[120:123], v[36:39], v[28:31]
  ds_read_b128 v[32:35], v60 offset:6144
  s_waitcnt lgkmcnt(10)
  v_mfma_f32_16x16x32_bf16 v[24:27], v[100:103], v[40:43], v[24:27]
  v_mfma_f32_16x16x32_bf16 v[28:31], v[116:119], v[40:43], v[28:31]
  ds_read_b128 v[36:39], v61 offset:6144
  s_waitcnt lgkmcnt(10)
  v_mfma_f32_16x16x32_bf16 v[24:27], v[96:99], v[44:47], v[24:27]
  v_mfma_f32_16x16x32_bf16 v[28:31], v[112:115], v[44:47], v[28:31]
  ds_read_b128 v[40:43], v60 offset:6656
  s_waitcnt lgkmcnt(10)
  v_mfma_f32_16x16x32_bf16 v[24:27], v[92:95], v[48:51], v[24:27]
  v_mfma_f32_16x16x32_bf16 v[28:31], v[108:111], v[48:51], v[28:31]
  ds_read_b128 v[44:47], v61 offset:6656
  s_waitcnt lgkmcnt(10)
  v_mfma_f32_16x16x32_bf16 v[24:27], v[88:91], v[52:55], v[24:27]
  v_mfma_f32_16x16x32_bf16 v[28:31], v[104:107], v[52:55], v[28:31]
  s_waitcnt lgkmcnt(9)
  v_mfma_f32_16x16x32_bf16 v[24:27], v[84:87], v[192:195], v[24:27]
  v_mfma_f32_16x16x32_bf16 v[28:31], v[100:103], v[192:195], v[28:31]
  s_waitcnt lgkmcnt(8)
  v_mfma_f32_16x16x32_bf16 v[24:27], v[80:83], v[196:199], v[24:27]
  v_mfma_f32_16x16x32_bf16 v[28:31], v[96:99], v[196:199], v[28:31]
  s_waitcnt lgkmcnt(7)
  v_mfma_f32_16x16x32_bf16 v[24:27], v[76:79], v[200:203], v[24:27]
  v_mfma_f32_16x16x32_bf16 v[28:31], v[92:95], v[200:203], v[28:31]
  s_waitcnt lgkmcnt(6)
  v_mfma_f32_16x16x32_bf16 v[24:27], v[72:75], v[204:207], v[24:27]
  v_mfma_f32_16x16x32_bf16 v[28:31], v[88:91], v[204:207], v[28:31]
  s_waitcnt lgkmcnt(5)
  v_mfma_f32_16x16x32_bf16 v[24:27], v[68:71], v[208:211], v[24:27]
  v_mfma_f32_16x16x32_bf16 v[28:31], v[84:87], v[208:211], v[28:31]
  s_waitcnt lgkmcnt(4)
  v_mfma_f32_16x16x32_bf16 v[24:27], v[64:67], v[224:227], v[24:27]
  v_mfma_f32_16x16x32_bf16 v[28:31], v[80:83], v[224:227], v[28:31]
  s_waitcnt lgkmcnt(3)
  v_mfma_f32_16x16x32_bf16 v[28:31], v[76:79], v[32:35], v[28:31]
  s_waitcnt lgkmcnt(2)
  v_mfma_f32_16x16x32_bf16 v[28:31], v[72:75], v[36:39], v[28:31]
  s_waitcnt lgkmcnt(1)
  v_mfma_f32_16x16x32_bf16 v[28:31], v[68:71], v[40:43], v[28:31]
  s_waitcnt lgkmcnt(0)
  v_mfma_f32_16x16x32_bf16 v[28:31], v[64:67], v[44:47], v[28:31]
  s_lshl_b32 s6, s3, 11
  v_add_u32 v5, s6, v2
  ds_write_b128 v5, v[16:19] offset:9472
  ds_write_b128 v5, v[20:23] offset:10496
  s_waitcnt lgkmcnt(0)
  s_barrier
  v_xor_b32 v5, 2048, v5
  ds_read_b128 v[32:35], v5 offset:9472
  ds_read_b128 v[36:39], v5 offset:10496
  s_waitcnt lgkmcnt(1)
  v_add_f32 v24, v24, v32
  v_add_f32 v25, v25, v33
  v_add_f32 v26, v26, v34
  v_add_f32 v27, v27, v35
  v_cvt_pk_bf16_f32 v48, v24, v25
  v_cvt_pk_bf16_f32 v49, v26, v27
  ds_write_b64 v62, v[48:49] offset:31616
  s_waitcnt lgkmcnt(1)
  v_add_f32 v28, v28, v36
  v_add_f32 v29, v29, v37
  v_add_f32 v30, v30, v38
  v_add_f32 v31, v31, v39
  v_cvt_pk_bf16_f32 v50, v28, v29
  v_cvt_pk_bf16_f32 v51, v30, v31
  ds_write_b64 v62, v[50:51] offset:32768
  s_waitcnt lgkmcnt(0)
L_vjoin:
  v_lshrrev_b32 v40, 3, v0
  v_mul_u32_u24 v42, 144, v40
  v_lshlrev_b32 v40, 15, v40
  v_and_b32 v41, 7, v0
  v_lshl_add_u32 v40, v41, 4, v40
  v_lshl_add_u32 v42, v41, 4, v42
  s_lshl_b32 s89, s2, 7
  s_add_u32 s89, s89, 8388608
  s_barrier
  ds_read_b128 v[16:19], v42 offset:25856
  s_waitcnt lgkmcnt(0)
  buffer_store_dwordx4 v[16:19], v40, s[8:11], s89 offen sc1
  v_mov_b32 v61, v13
  v_lshlrev_b32 v13, 5, v1
  v_add_u32 v13, 155648, v13
  s_lshl_b32 s6, s3, 2
  v_add_u32 v59, s6, v13
  s_mov_b32 s5, 2363392
  buffer_load_dword v25, v7, s[8:11], s5 offen sc1
  v_bfe_u32 v24, v1, 1, 3
  v_xor_b32 v24, v24, v4
  v_lshlrev_b32 v24, 4, v24
  v_lshl_add_u32 v24, v3, 7, v24
  s_add_u32 s6, s95, 98304
  v_add_u32 v24, s6, v24
  s_waitcnt vmcnt(5)
  v_xor_b32 v20, 0, v24
  ds_read_b128 v[128:131], v20
  v_xor_b32 v21, 32, v24
  ds_read_b128 v[132:135], v21
  v_xor_b32 v22, 64, v24
  ds_read_b128 v[136:139], v22
  v_xor_b32 v23, 96, v24
  ds_read_b128 v[140:143], v23
  s_waitcnt lgkmcnt(3)
  v_permlane32_swap_b32 v128, v130
  v_permlane32_swap_b32 v129, v131
  s_waitcnt lgkmcnt(2)
  v_permlane32_swap_b32 v132, v134
  v_permlane32_swap_b32 v133, v135
  s_waitcnt lgkmcnt(1)
  v_permlane32_swap_b32 v136, v138
  v_permlane32_swap_b32 v137, v139
  s_waitcnt lgkmcnt(0)
  v_permlane32_swap_b32 v140, v142
  v_permlane32_swap_b32 v141, v143
  v_mov_b32 v44, 0
  v_mov_b32 v45, 0
  v_mov_b32 v46, 0
  v_mov_b32 v47, 0
  v_dot2_f32_bf16 v44, v128, v8, v44
  v_dot2_f32_bf16 v46, v128, v128, v46
  v_dot2_f32_bf16 v45, v129, v8, v45
  v_dot2_f32_bf16 v47, v129, v129, v47
  v_dot2_f32_bf16 v44, v130, v8, v44
  v_dot2_f32_bf16 v46, v130, v130, v46
  v_dot2_f32_bf16 v45, v131, v8, v45
  v_dot2_f32_bf16 v47, v131, v131, v47
  v_dot2_f32_bf16 v44, v132, v8, v44
  v_dot2_f32_bf16 v46, v132, v132, v46
  v_dot2_f32_bf16 v45, v133, v8, v45
  v_dot2_f32_bf16 v47, v133, v133, v47
  v_dot2_f32_bf16 v44, v134, v8, v44
  v_dot2_f32_bf16 v46, v134, v134, v46
  v_dot2_f32_bf16 v45, v135, v8, v45
  v_dot2_f32_bf16 v47, v135, v135, v47
  v_dot2_f32_bf16 v44, v136, v8, v44
  v_dot2_f32_bf16 v46, v136, v136, v46
  v_dot2_f32_bf16 v45, v137, v8, v45
  v_dot2_f32_bf16 v47, v137, v137, v47
  v_dot2_f32_bf16 v44, v138, v8, v44
  v_dot2_f32_bf16 v46, v138, v138, v46
  v_dot2_f32_bf16 v45, v139, v8, v45
  v_dot2_f32_bf16 v47, v139, v139, v47
  v_dot2_f32_bf16 v44, v140, v8, v44
  v_dot2_f32_bf16 v46, v140, v140, v46
  v_dot2_f32_bf16 v45, v141, v8, v45
  v_dot2_f32_bf16 v47, v141, v141, v47
  v_dot2_f32_bf16 v44, v142, v8, v44
  v_dot2_f32_bf16 v46, v142, v142, v46
  v_dot2_f32_bf16 v45, v143, v8, v45
  v_dot2_f32_bf16 v47, v143, v143, v47
  s_nop 1
  v_add_f32 v44, v44, v45
  v_add_f32 v46, v46, v47
  s_nop 1
  v_permlane32_swap_b32 v44, v46
  v_add_f32 v44, v44, v46
  ds_write_b32 v59, v44 offset:0
  s_waitcnt lgkmcnt(0)
  s_waitcnt vmcnt(0)
  v_cmp_ne_u32 vcc, s56, v25
  s_cbranch_vccz L_polld1
  s_mov_b32 s5, 2363392
  s_mov_b32 s6, 0
L_poll1:
  buffer_load_dword v25, v7, s[8:11], s5 offen sc1
  s_add_u32 s6, s6, 1
  s_waitcnt vmcnt(0)
  v_cmp_ne_u32 vcc, s56, v25
  s_cbranch_vccz L_polld1
  s_sleep 1
  s_cmp_lt_u32 s6, 0x40000
  s_cbranch_scc1 L_poll1
L_polld1:
  s_barrier
  s_lshl_b32 s4, s2, 4
  s_add_u32 s4, s4, 2367488
  s_cmp_lg_u32 s3, 0
  s_cselect_b32 s4, 2146435072, s4
  v_mov_b32 v5, s56
  buffer_store_dword v5, v14, s[8:11], s4 offen sc1
  s_mov_b32 s7, 2097152
  buffer_load_dwordx4 v[64:67], v63, s[8:11], s7 offen sc1
  s_mov_b32 s7, 2105344
  buffer_load_dwordx4 v[68:71], v63, s[8:11], s7 offen sc1
  s_mov_b32 s7, 2113536
  buffer_load_dwordx4 v[72:75], v63, s[8:11], s7 offen sc1
  s_mov_b32 s7, 2121728
  buffer_load_dwordx4 v[76:79], v63, s[8:11], s7 offen sc1
  s_mov_b32 s7, 2129920
  buffer_load_dwordx4 v[80:83], v63, s[8:11], s7 offen sc1
  s_lshr_b32 s6, s57, 1
  s_and_b32 s7, s57, 1
  s_lshl_b32 s7, s7, 1
  s_add_i32 s7, s7, -1
  s_add_i32 s7, s7, s6
  s_max_i32 s7, s7, 0
  s_min_i32 s7, s7, 31
  v_mov_b32 v5, s7
  v_mov_b32 v6, s6
  v_bfe_u32 v38, v1, 3, 2
  v_cmp_eq_u32 vcc, 1, v38
  s_nop 1
  v_cndmask_b32 v5, v5, v6, vcc
  v_mov_b32 v6, s59
  v_cmp_eq_u32 vcc, 0, v38
  s_nop 1
  v_cndmask_b32 v5, v5, v6, vcc
  v_and_b32 v6, 7, v1
  v_lshl_add_u32 v6, v5, 3, v6
  v_lshlrev_b32 v6, 4, v6
  s_mov_b32 s7, 2363396
  buffer_load_dword v39, v6, s[8:11], s7 offen sc1
  s_and_b32 s83, s3, 1
  s_lshr_b32 s84, s3, 1
  s_lshl_b32 s6, s60, 1
  s_add_u32 s85, s6, s83
  s_lshl_b32 s6, s60, 3
  s_add_u32 s81, s6, s3
  s_lshl_b32 s82, s81, 15
  s_add_u32 s82, s82, 4194304
  s_cmp_eq_u32 s60, 7
  s_cselect_b32 s82, 2146435072, s82
  s_lshl_b32 s88, s85, 15
  s_lshl_b32 s7, s84, 13
  s_add_u32 s88, s88, s7
  s_add_u32 s88, s88, 3670016
  ds_read_b128 v[48:51], v13 offset:0
  ds_read_b128 v[52:55], v13 offset:16
  s_waitcnt lgkmcnt(1)
  v_add_f32 v48, v48, v49
  v_add_f32 v50, v50, v51
  s_waitcnt lgkmcnt(0)
  v_add_f32 v52, v52, v53
  v_add_f32 v54, v54, v55
  v_add_f32 v48, v48, v50
  v_add_f32 v52, v52, v54
  v_add_f32 v48, v48, v52
  v_mov_b32 v49, v48
  s_nop 1
  v_permlane32_swap_b32 v48, v49
  v_mul_f32 v56, 0x3b000000, v48
  v_mul_f32 v49, 0x3b000000, v49
  v_fma_f32 v49, -v56, v56, v49
  v_max_f32 v49, 0, v49
  v_add_f32 v49, 0x3727c5ac, v49
  v_rsq_f32 v57, v49
  s_nop 0
  v_mul_f32 v56, v56, v57
  v_lshlrev_b32 v16, 16, v128
  v_and_b32 v128, 0xffff0000, v128
  v_fma_f32 v144, v16, v57, -v56
  v_fma_f32 v145, v128, v57, -v56
  v_lshlrev_b32 v17, 16, v129
  v_and_b32 v129, 0xffff0000, v129
  v_fma_f32 v146, v17, v57, -v56
  v_fma_f32 v147, v129, v57, -v56
  buffer_load_dwordx4 v[192:195], v2, s[8:11], s80 offen offset:0 sc1
  v_lshlrev_b32 v18, 16, v130
  v_and_b32 v130, 0xffff0000, v130
  v_fma_f32 v148, v18, v57, -v56
  v_fma_f32 v149, v130, v57, -v56
  v_lshlrev_b32 v19, 16, v131
  v_and_b32 v131, 0xffff0000, v131
  v_fma_f32 v150, v19, v57, -v56
  v_fma_f32 v151, v131, v57, -v56
  v_lshlrev_b32 v20, 16, v132
  v_and_b32 v132, 0xffff0000, v132
  v_fma_f32 v152, v20, v57, -v56
  v_fma_f32 v153, v132, v57, -v56
  v_lshlrev_b32 v21, 16, v133
  v_and_b32 v133, 0xffff0000, v133
  v_fma_f32 v154, v21, v57, -v56
  v_fma_f32 v155, v133, v57, -v56
  buffer_load_dwordx4 v[196:199], v2, s[8:11], s80 offen offset:1024 sc1
  v_lshlrev_b32 v22, 16, v134
  v_and_b32 v134, 0xffff0000, v134
  v_fma_f32 v156, v22, v57, -v56
  v_fma_f32 v157, v134, v57, -v56
  v_lshlrev_b32 v23, 16, v135
  v_and_b32 v135, 0xffff0000, v135
  v_fma_f32 v158, v23, v57, -v56
  v_fma_f32 v159, v135, v57, -v56
  v_lshlrev_b32 v24, 16, v136
  v_and_b32 v136, 0xffff0000, v136
  v_fma_f32 v160, v24, v57, -v56
  v_fma_f32 v161, v136, v57, -v56
  v_lshlrev_b32 v25, 16, v137
  v_and_b32 v137, 0xffff0000, v137
  v_fma_f32 v162, v25, v57, -v56
  v_fma_f32 v163, v137, v57, -v56
  buffer_load_dwordx4 v[200:203], v2, s[8:11], s80 offen offset:2048 sc1
  v_lshlrev_b32 v26, 16, v138
  v_and_b32 v138, 0xffff0000, v138
  v_fma_f32 v164, v26, v57, -v56
  v_fma_f32 v165, v138, v57, -v56
  v_lshlrev_b32 v27, 16, v139
  v_and_b32 v139, 0xffff0000, v139
  v_fma_f32 v166, v27, v57, -v56
  v_fma_f32 v167, v139, v57, -v56
  v_lshlrev_b32 v28, 16, v140
  v_and_b32 v140, 0xffff0000, v140
  v_fma_f32 v168, v28, v57, -v56
  v_fma_f32 v169, v140, v57, -v56
  v_lshlrev_b32 v29, 16, v141
  v_and_b32 v141, 0xffff0000, v141
  v_fma_f32 v170, v29, v57, -v56
  v_fma_f32 v171, v141, v57, -v56
  buffer_load_dwordx4 v[204:207], v2, s[8:11], s80 offen offset:3072 sc1
  v_lshlrev_b32 v30, 16, v142
  v_and_b32 v142, 0xffff0000, v142
  v_fma_f32 v172, v30, v57, -v56
  v_fma_f32 v173, v142, v57, -v56
  v_lshlrev_b32 v31, 16, v143
  v_and_b32 v143, 0xffff0000, v143
  v_fma_f32 v174, v31, v57, -v56
  v_fma_f32 v175, v143, v57, -v56
  s_lshl_b32 s6, s3, 8
  s_add_u32 s6, s6, 131072
  v_lshl_add_u32 v62, v4, 4, s6
  v_lshl_add_u32 v58, v1, 2, s6
  s_waitcnt vmcnt(9)
  v_add_f32 v64, v64, v65
  v_add_f32 v66, v66, v67
  v_add_f32 v64, v64, v66
  s_waitcnt vmcnt(8)
  v_add_f32 v68, v68, v69
  v_add_f32 v70, v70, v71
  v_add_f32 v68, v68, v70
  s_waitcnt vmcnt(7)
  v_add_f32 v72, v72, v73
  v_add_f32 v74, v74, v75
  v_add_f32 v72, v72, v74
  s_waitcnt vmcnt(6)
  v_add_f32 v76, v76, v77
  v_add_f32 v78, v78, v79
  v_add_f32 v76, v76, v78
  s_waitcnt vmcnt(5)
  v_add_f32 v80, v80, v81
  v_add_f32 v82, v82, v83
  v_add_f32 v80, v80, v82
  v_cvt_pk_bf16_f32 v52, v64, v68
  v_lshlrev_b32 v64, 16, v52
  v_and_b32 v68, 0xffff0000, v52
  v_cvt_pk_bf16_f32 v52, v72, v76
  v_lshlrev_b32 v72, 16, v52
  v_and_b32 v76, 0xffff0000, v52
  v_cvt_pk_bf16_f32 v52, v80, v81
  v_lshlrev_b32 v80, 16, v52
  v_and_b32 v81, 0xffff0000, v52
  v_add_f32 v68, 1.0, v68
  v_add_f32 v80, 1.0, v80
  v_cvt_pk_bf16_f32 v52, v68, v80
  v_lshlrev_b32 v68, 16, v52
  v_and_b32 v80, 0xffff0000, v52
  v_mul_f32 v68, v68, v72
  v_mul_f32 v64, v64, v72
  ds_write_b32 v58, v68 offset:0
  ds_write_b32 v58, v64 offset:2048
  ds_write_b32 v58, v80 offset:4096
  ds_write_b32 v58, v76 offset:6144
  s_waitcnt vmcnt(4)
  v_cmp_eq_u32 vcc, s62, v39
  s_nop 4
  s_and_b32 s6, vcc_lo, 0xff
  s_cmp_eq_u32 s6, 0xff
  s_cselect_b32 s87, 1, 0
  s_and_b32 s6, vcc_lo, 0xffff00
  s_cmp_eq_u32 s6, 0xffff00
  s_cselect_b32 s63, 1, 0
  s_mov_b32 s63, 0
  v_add_u32 v48, s72, v61
  ds_read_b64_tr_b16 v[40:41], v48 offset:0
  ds_read_b64_tr_b16 v[42:43], v48 offset:1024
  ds_read_b64_tr_b16 v[44:45], v48 offset:64
  ds_read_b64_tr_b16 v[46:47], v48 offset:1088
  s_add_u32 s4, s73, s74
  s_waitcnt lgkmcnt(2)
  buffer_store_dwordx4 v[40:43], v2, s[8:11], s73 offen sc1
  s_waitcnt lgkmcnt(0)
  buffer_store_dwordx4 v[44:47], v2, s[8:11], s4 offen sc1
  s_add_u32 s7, s80, 4096
  buffer_load_dwordx4 v[208:211], v2, s[8:11], s7 offen offset:0 sc1
  s_add_u32 s7, s80, 4096
  buffer_load_dwordx4 v[212:215], v2, s[8:11], s7 offen offset:1024 sc1
  s_add_u32 s7, s80, 4096
  buffer_load_dwordx4 v[216:219], v2, s[8:11], s7 offen offset:2048 sc1
  s_add_u32 s7, s80, 4096
  buffer_load_dwordx4 v[220:223], v2, s[8:11], s7 offen offset:3072 sc1
  s_mov_b32 s5, 2367488
  buffer_load_dword v58, v7, s[8:11], s5 offen sc1
  ds_read_b128 v[64:67], v62 offset:0
  ds_read_b128 v[68:71], v62 offset:2048
  ds_read_b128 v[72:75], v62 offset:32
  ds_read_b128 v[76:79], v62 offset:2080
  ds_read_b128 v[80:83], v62 offset:64
  ds_read_b128 v[84:87], v62 offset:2112
  ds_read_b128 v[88:91], v62 offset:96
  ds_read_b128 v[92:95], v62 offset:2144
  ds_read_b128 v[96:99], v62 offset:128
  ds_read_b128 v[100:103], v62 offset:2176
  ds_read_b128 v[104:107], v62 offset:160
  ds_read_b128 v[108:111], v62 offset:2208
  ds_read_b128 v[112:115], v62 offset:192
  ds_read_b128 v[116:119], v62 offset:2240
  ds_read_b128 v[120:123], v62 offset:224
  ds_read_b128 v[124:127], v62 offset:2272
  v_and_b32 v60, 3, v1
  v_lshlrev_b32 v60, 3, v60
  v_bfe_u32 v61, v1, 2, 2
  v_lshl_add_u32 v61, v4, 2, v61
  v_lshl_add_u32 v60, v61, 6, v60
  v_bfe_u32 v61, v1, 4, 1
  v_lshl_add_u32 v60, v61, 5, v60
  s_lshl_b32 s89, s3, 12
  v_add_u32 v60, s89, v60
  v_add_u32 v61, s89, v2
  s_lshl_b32 s90, s57, 15
  s_add_u32 s90, s90, s89
  s_add_u32 s91, s90, 8388608
  s_add_u32 s93, s90, 10485760
  s_add_u32 s93, s93, s96
  s_add_u32 s94, s90, 10551296
  s_add_u32 s94, s94, s96
  s_waitcnt lgkmcnt(14)
  v_fma_f32 v144, v144, v64, v68
  v_fma_f32 v145, v145, v65, v69
  v_fma_f32 v146, v146, v66, v70
  v_fma_f32 v147, v147, v67, v71
  s_waitcnt lgkmcnt(12)
  v_fma_f32 v148, v148, v72, v76
  v_fma_f32 v149, v149, v73, v77
  v_fma_f32 v150, v150, v74, v78
  v_fma_f32 v151, v151, v75, v79
  s_waitcnt lgkmcnt(10)
  v_fma_f32 v152, v152, v80, v84
  v_fma_f32 v153, v153, v81, v85
  v_fma_f32 v154, v154, v82, v86
  v_fma_f32 v155, v155, v83, v87
  s_waitcnt lgkmcnt(8)
  v_fma_f32 v156, v156, v88, v92
  v_fma_f32 v157, v157, v89, v93
  v_fma_f32 v158, v158, v90, v94
  v_fma_f32 v159, v159, v91, v95
  s_waitcnt lgkmcnt(6)
  v_fma_f32 v160, v160, v96, v100
  v_fma_f32 v161, v161, v97, v101
  v_fma_f32 v162, v162, v98, v102
  v_fma_f32 v163, v163, v99, v103
  s_waitcnt lgkmcnt(4)
  v_fma_f32 v164, v164, v104, v108
  v_fma_f32 v165, v165, v105, v109
  v_fma_f32 v166, v166, v106, v110
  v_fma_f32 v167, v167, v107, v111
  s_waitcnt lgkmcnt(2)
  v_fma_f32 v168, v168, v112, v116
  v_fma_f32 v169, v169, v113, v117
  v_fma_f32 v170, v170, v114, v118
  v_fma_f32 v171, v171, v115, v119
  s_waitcnt lgkmcnt(0)
  v_fma_f32 v172, v172, v120, v124
  v_fma_f32 v173, v173, v121, v125
  v_fma_f32 v174, v174, v122, v126
  v_fma_f32 v175, v175, v123, v127
  s_waitcnt vmcnt(0)
  v_cmp_ne_u32 vcc, s56, v58
  s_cbranch_vccz L_polld2
  s_mov_b32 s5, 2367488
  s_mov_b32 s6, 0
L_poll2:
  buffer_load_dword v58, v7, s[8:11], s5 offen sc1
  s_add_u32 s6, s6, 1
  s_waitcnt vmcnt(0)
  v_cmp_ne_u32 vcc, s56, v58
  s_cbranch_vccz L_polld2
  s_sleep 1
  s_cmp_lt_u32 s6, 0x40000
  s_cbranch_scc1 L_poll2
L_polld2:
  s_add_u32 m0, s89, 0
  s_nop 0
  buffer_load_dwordx4 v2, s[8:11], s91 offen offset:0 sc1 lds
  buffer_load_dwordx4 v2, s[8:11], s91 offen offset:1024 sc1 lds
  buffer_load_dwordx4 v2, s[8:11], s91 offen offset:2048 sc1 lds
  buffer_load_dwordx4 v2, s[8:11], s91 offen offset:3072 sc1 lds
  s_add_u32 s7, s80, 8192
  buffer_load_dwordx4 v[224:227], v2, s[8:11], s7 offen offset:0 sc1
  s_add_u32 s7, s80, 8192
  buffer_load_dwordx4 v[228:231], v2, s[8:11], s7 offen offset:1024 sc1
  s_add_u32 s7, s80, 8192
  buffer_load_dwordx4 v[232:235], v2, s[8:11], s7 offen offset:2048 sc1
  s_add_u32 s7, s80, 8192
  buffer_load_dwordx4 v[236:239], v2, s[8:11], s7 offen offset:3072 sc1
  v_mfma_f32_32x32x16_bf16 v[32:47], v[192:195], v[8:11], 0
  v_mfma_f32_32x32x16_bf16 v[32:47], v[196:199], v[8:11], v[32:47]
  v_mfma_f32_32x32x16_bf16 v[32:47], v[200:203], v[8:11], v[32:47]
  v_mfma_f32_32x32x16_bf16 v[32:47], v[204:207], v[8:11], v[32:47]
  v_mfma_f32_32x32x16_bf16 v[32:47], v[208:211], v[8:11], v[32:47]
  v_mfma_f32_32x32x16_bf16 v[32:47], v[212:215], v[8:11], v[32:47]
  v_mfma_f32_32x32x16_bf16 v[32:47], v[216:219], v[8:11], v[32:47]
  v_mfma_f32_32x32x16_bf16 v[32:47], v[220:223], v[8:11], v[32:47]
  ds_read_b128 v[64:67], v62 offset:4096
  ds_read_b128 v[68:71], v62 offset:6144
  ds_read_b128 v[72:75], v62 offset:4128
  ds_read_b128 v[76:79], v62 offset:6176
  ds_read_b128 v[80:83], v62 offset:4160
  ds_read_b128 v[84:87], v62 offset:6208
  ds_read_b128 v[88:91], v62 offset:4192
  ds_read_b128 v[92:95], v62 offset:6240
  v_mov_b32 v48, 0
  v_mov_b32 v49, 0
  v_mov_b32 v50, 0
  v_mov_b32 v51, 0
  s_waitcnt vmcnt(4)
  ds_read_b64_tr_b16 v[176:177], v60 offset:0
  ds_read_b64_tr_b16 v[178:179], v60 offset:512
  ds_read_b64_tr_b16 v[180:181], v60 offset:1024
  ds_read_b64_tr_b16 v[182:183], v60 offset:1536
  ds_read_b64_tr_b16 v[184:185], v60 offset:2048
  ds_read_b64_tr_b16 v[186:187], v60 offset:2560
  ds_read_b64_tr_b16 v[188:189], v60 offset:3072
  ds_read_b64_tr_b16 v[190:191], v60 offset:3584
  s_cmp_ge_u32 s3, 4
  s_cbranch_scc1 L_b_s1
  s_add_u32 s7, s80, 12288
  buffer_load_dwordx4 v[240:243], v2, s[8:11], s7 offen offset:0 sc1
  s_add_u32 s7, s80, 12288
  buffer_load_dwordx4 v[244:247], v2, s[8:11], s7 offen offset:1024 sc1
  s_add_u32 s7, s80, 12288
  buffer_load_dwordx4 v[248:251], v2, s[8:11], s7 offen offset:2048 sc1
  s_add_u32 s7, s80, 12288
  buffer_load_dwordx4 v[252:255], v2, s[8:11], s7 offen offset:3072 sc1
L_b_s1:
  s_nop 0
  s_waitcnt lgkmcnt(7)
  v_lshlrev_b32 v52, 16, v176
  v_and_b32 v53, 0xffff0000, v176
  v_fmac_f32 v16, v144, v52
  v_fmac_f32 v128, v145, v53
  v_cvt_pk_bf16_f32 v176, v16, v128
  v_lshlrev_b32 v54, 16, v177
  v_and_b32 v55, 0xffff0000, v177
  v_fmac_f32 v17, v146, v54
  v_fmac_f32 v129, v147, v55
  v_cvt_pk_bf16_f32 v177, v17, v129
  v_dot2_f32_bf16 v49, v176, v8, v49
  v_dot2_f32_bf16 v51, v176, v176, v51
  s_waitcnt lgkmcnt(6)
  v_lshlrev_b32 v52, 16, v178
  v_and_b32 v53, 0xffff0000, v178
  v_fmac_f32 v18, v148, v52
  v_fmac_f32 v130, v149, v53
  v_cvt_pk_bf16_f32 v178, v18, v130
  v_dot2_f32_bf16 v48, v177, v8, v48
  v_dot2_f32_bf16 v50, v177, v177, v50
  v_lshlrev_b32 v54, 16, v179
  v_and_b32 v55, 0xffff0000, v179
  v_fmac_f32 v19, v150, v54
  v_fmac_f32 v131, v151, v55
  v_cvt_pk_bf16_f32 v179, v19, v131
  v_dot2_f32_bf16 v49, v178, v8, v49
  v_dot2_f32_bf16 v51, v178, v178, v51
  s_waitcnt lgkmcnt(5)
  v_lshlrev_b32 v52, 16, v180
  v_and_b32 v53, 0xffff0000, v180
  v_fmac_f32 v20, v152, v52
  v_fmac_f32 v132, v153, v53
  v_cvt_pk_bf16_f32 v180, v20, v132
  v_dot2_f32_bf16 v48, v179, v8, v48
  v_dot2_f32_bf16 v50, v179, v179, v50
  v_lshlrev_b32 v54, 16, v181
  v_and_b32 v55, 0xffff0000, v181
  v_fmac_f32 v21, v154, v54
  v_fmac_f32 v133, v155, v55
  v_cvt_pk_bf16_f32 v181, v21, v133
  v_dot2_f32_bf16 v49, v180, v8, v49
  v_dot2_f32_bf16 v51, v180, v180, v51
  s_waitcnt lgkmcnt(4)
  v_lshlrev_b32 v52, 16, v182
  v_and_b32 v53, 0xffff0000, v182
  v_fmac_f32 v22, v156, v52
  v_fmac_f32 v134, v157, v53
  v_cvt_pk_bf16_f32 v182, v22, v134
  v_dot2_f32_bf16 v48, v181, v8, v48
  v_dot2_f32_bf16 v50, v181, v181, v50
  v_lshlrev_b32 v54, 16, v183
  v_and_b32 v55, 0xffff0000, v183
  v_fmac_f32 v23, v158, v54
  v_fmac_f32 v135, v159, v55
  v_cvt_pk_bf16_f32 v183, v23, v135
  v_dot2_f32_bf16 v49, v182, v8, v49
  v_dot2_f32_bf16 v51, v182, v182, v51
  s_waitcnt lgkmcnt(3)
  v_lshlrev_b32 v52, 16, v184
  v_and_b32 v53, 0xffff0000, v184
  v_fmac_f32 v24, v160, v52
  v_fmac_f32 v136, v161, v53
  v_cvt_pk_bf16_f32 v184, v24, v136
  v_dot2_f32_bf16 v48, v183, v8, v48
  v_dot2_f32_bf16 v50, v183, v183, v50
  v_lshlrev_b32 v54, 16, v185
  v_and_b32 v55, 0xffff0000, v185
  v_fmac_f32 v25, v162, v54
  v_fmac_f32 v137, v163, v55
  v_cvt_pk_bf16_f32 v185, v25, v137
  v_dot2_f32_bf16 v49, v184, v8, v49
  v_dot2_f32_bf16 v51, v184, v184, v51
  s_waitcnt lgkmcnt(2)
  v_lshlrev_b32 v52, 16, v186
  v_and_b32 v53, 0xffff0000, v186
  v_fmac_f32 v26, v164, v52
  v_fmac_f32 v138, v165, v53
  v_cvt_pk_bf16_f32 v186, v26, v138
  v_dot2_f32_bf16 v48, v185, v8, v48
  v_dot2_f32_bf16 v50, v185, v185, v50
  v_lshlrev_b32 v54, 16, v187
  v_and_b32 v55, 0xffff0000, v187
  v_fmac_f32 v27, v166, v54
  v_fmac_f32 v139, v167, v55
  v_cvt_pk_bf16_f32 v187, v27, v139
  v_dot2_f32_bf16 v49, v186, v8, v49
  v_dot2_f32_bf16 v51, v186, v186, v51
  s_waitcnt lgkmcnt(1)
  v_lshlrev_b32 v52, 16, v188
  v_and_b32 v53, 0xffff0000, v188
  v_fmac_f32 v28, v168, v52
  v_fmac_f32 v140, v169, v53
  v_cvt_pk_bf16_f32 v188, v28, v140
  v_dot2_f32_bf16 v48, v187, v8, v48
  v_dot2_f32_bf16 v50, v187, v187, v50
  v_lshlrev_b32 v54, 16, v189
  v_and_b32 v55, 0xffff0000, v189
  v_fmac_f32 v29, v170, v54
  v_fmac_f32 v141, v171, v55
  v_cvt_pk_bf16_f32 v189, v29, v141
  v_dot2_f32_bf16 v49, v188, v8, v49
  v_dot2_f32_bf16 v51, v188, v188, v51
  s_waitcnt lgkmcnt(0)
  v_lshlrev_b32 v52, 16, v190
  v_and_b32 v53, 0xffff0000, v190
  v_fmac_f32 v30, v172, v52
  v_fmac_f32 v142, v173, v53
  v_cvt_pk_bf16_f32 v190, v30, v142
  v_dot2_f32_bf16 v48, v189, v8, v48
  v_dot2_f32_bf16 v50, v189, v189, v50
  v_lshlrev_b32 v54, 16, v191
  v_and_b32 v55, 0xffff0000, v191
  v_fmac_f32 v31, v174, v54
  v_fmac_f32 v143, v175, v55
  v_cvt_pk_bf16_f32 v191, v31, v143
  v_dot2_f32_bf16 v49, v190, v8, v49
  v_dot2_f32_bf16 v51, v190, v190, v51
  v_dot2_f32_bf16 v48, v191, v8, v48
  v_dot2_f32_bf16 v50, v191, v191, v50
  s_nop 1
  v_add_f32 v48, v48, v49
  v_add_f32 v50, v50, v51
  s_nop 1
  v_permlane32_swap_b32 v48, v50
  v_add_f32 v48, v48, v50
  ds_write_b32 v59, v48 offset:2048
  s_cmp_lt_u32 s3, 4
  s_cbranch_scc1 L_b_s2
  s_add_u32 s7, s80, 12288
  buffer_load_dwordx4 v[240:243], v2, s[8:11], s7 offen offset:0 sc1
  s_add_u32 s7, s80, 12288
  buffer_load_dwordx4 v[244:247], v2, s[8:11], s7 offen offset:1024 sc1
  s_add_u32 s7, s80, 12288
  buffer_load_dwordx4 v[248:251], v2, s[8:11], s7 offen offset:2048 sc1
  s_add_u32 s7, s80, 12288
  buffer_load_dwordx4 v[252:255], v2, s[8:11], s7 offen offset:3072 sc1
L_b_s2:
  s_nop 0
  s_waitcnt lgkmcnt(0)
  s_barrier
  ds_read_b128 v[48:51], v13 offset:2048
  ds_read_b128 v[52:55], v13 offset:2064
  s_cmp_lg_u32 s3, 0
  s_cbranch_scc1 L_b_nf
  s_or_b32 s6, s2, s3
  s_cmp_lg_u32 s6, 0
  s_mov_b32 s7, 2555904
  s_cselect_b32 s6, 2146435072, s7
  v_mov_b32 v5, s56
  buffer_store_dword v5, v14, s[8:11], s6 offen sc1
  s_lshl_b32 s4, s2, 4
  s_add_u32 s4, s4, 2387968
  s_cmp_lg_u32 s3, 0
  s_cselect_b32 s4, 2146435072, s4
  v_mov_b32 v5, s56
  buffer_store_dword v5, v14, s[8:11], s4 offen sc1
L_b_nf:
  s_nop 0
  s_cmp_lg_u32 s84, s58
  s_cbranch_scc1 L_b_sx
  buffer_store_dwordx4 v[176:179], v2, s[8:11], s93 offen offset:0 sc1
  buffer_store_dwordx4 v[180:183], v2, s[8:11], s93 offen offset:1024 sc1
  buffer_store_dwordx4 v[184:187], v2, s[8:11], s93 offen offset:2048 sc1
  buffer_store_dwordx4 v[188:191], v2, s[8:11], s93 offen offset:3072 sc1
L_b_sx:
  s_nop 1
  s_cmp_ge_u32 s3, 4
  s_cbranch_scc1 L_b_s3
  buffer_load_dwordx4 v[96:99], v2, s[8:11], s88 offen offset:0 sc1
  buffer_load_dwordx4 v[100:103], v2, s[8:11], s88 offen offset:1024 sc1
  buffer_load_dwordx4 v[104:107], v2, s[8:11], s88 offen offset:2048 sc1
  buffer_load_dwordx4 v[108:111], v2, s[8:11], s88 offen offset:3072 sc1
L_b_s3:
  s_nop 0
  ds_read_b128 v[144:147], v62 offset:4224
  ds_read_b128 v[148:151], v62 offset:6272
  ds_read_b128 v[152:155], v62 offset:4256
  ds_read_b128 v[156:159], v62 offset:6304
  ds_read_b128 v[160:163], v62 offset:4288
  ds_read_b128 v[164:167], v62 offset:6336
  ds_read_b128 v[168:171], v62 offset:4320
  ds_read_b128 v[172:175], v62 offset:6368
  s_waitcnt lgkmcnt(9)
  v_add_f32 v48, v48, v49
  v_add_f32 v50, v50, v51
  s_waitcnt lgkmcnt(8)
  v_add_f32 v52, v52, v53
  v_add_f32 v54, v54, v55
  v_add_f32 v48, v48, v50
  v_add_f32 v52, v52, v54
  v_add_f32 v48, v48, v52
  v_mov_b32 v49, v48
  s_nop 1
  v_permlane32_swap_b32 v48, v49
  v_mul_f32 v56, 0x3b000000, v48
  v_mul_f32 v49, 0x3b000000, v49
  v_fma_f32 v49, -v56, v56, v49
  v_max_f32 v49, 0, v49
  v_add_f32 v49, 0x3727c5ac, v49
  v_rsq_f32 v57, v49
  s_nop 0
  v_mul_f32 v56, v56, v57
  v_mov_b32 v48, 0
  v_mov_b32 v49, 0
  v_mov_b32 v50, 0
  v_mov_b32 v51, 0
  v_fma_f32 v16, v16, v57, -v56
  v_fma_f32 v128, v128, v57, -v56
  v_fma_f32 v17, v17, v57, -v56
  v_fma_f32 v129, v129, v57, -v56
  v_fmac_f32 v68, v16, v64
  v_fmac_f32 v69, v128, v65
  v_fmac_f32 v70, v17, v66
  v_fmac_f32 v71, v129, v67
  v_cvt_pk_bf16_f32 v176, v68, v69
  v_cvt_pk_bf16_f32 v177, v70, v71
  v_fma_f32 v18, v18, v57, -v56
  v_fma_f32 v130, v130, v57, -v56
  v_fma_f32 v19, v19, v57, -v56
  v_fma_f32 v131, v131, v57, -v56
  v_fmac_f32 v76, v18, v72
  v_fmac_f32 v77, v130, v73
  v_fmac_f32 v78, v19, v74
  v_fmac_f32 v79, v131, v75
  v_cvt_pk_bf16_f32 v178, v76, v77
  v_cvt_pk_bf16_f32 v179, v78, v79
  v_dot2_f32_bf16 v48, v176, v8, v48
  v_dot2_f32_bf16 v50, v176, v176, v50
  v_dot2_f32_bf16 v49, v177, v8, v49
  v_dot2_f32_bf16 v51, v177, v177, v51
  ds_write_b128 v61, v[176:179] offset:0
  v_fma_f32 v20, v20, v57, -v56
  v_fma_f32 v132, v132, v57, -v56
  v_fma_f32 v21, v21, v57, -v56
  v_fma_f32 v133, v133, v57, -v56
  v_fmac_f32 v84, v20, v80
  v_fmac_f32 v85, v132, v81
  v_fmac_f32 v86, v21, v82
  v_fmac_f32 v87, v133, v83
  v_cvt_pk_bf16_f32 v180, v84, v85
  v_cvt_pk_bf16_f32 v181, v86, v87
  v_dot2_f32_bf16 v48, v178, v8, v48
  v_dot2_f32_bf16 v50, v178, v178, v50
  v_dot2_f32_bf16 v49, v179, v8, v49
  v_dot2_f32_bf16 v51, v179, v179, v51
  v_fma_f32 v22, v22, v57, -v56
  v_fma_f32 v134, v134, v57, -v56
  v_fma_f32 v23, v23, v57, -v56
  v_fma_f32 v135, v135, v57, -v56
  v_fmac_f32 v92, v22, v88
  v_fmac_f32 v93, v134, v89
  v_fmac_f32 v94, v23, v90
  v_fmac_f32 v95, v135, v91
  v_cvt_pk_bf16_f32 v182, v92, v93
  v_cvt_pk_bf16_f32 v183, v94, v95
  v_dot2_f32_bf16 v48, v180, v8, v48
  v_dot2_f32_bf16 v50, v180, v180, v50
  v_dot2_f32_bf16 v49, v181, v8, v49
  v_dot2_f32_bf16 v51, v181, v181, v51
  ds_write_b128 v61, v[180:183] offset:1024
  v_fma_f32 v24, v24, v57, -v56
  v_fma_f32 v136, v136, v57, -v56
  v_fma_f32 v25, v25, v57, -v56
  v_fma_f32 v137, v137, v57, -v56
  s_waitcnt lgkmcnt(8)
  v_fmac_f32 v148, v24, v144
  v_fmac_f32 v149, v136, v145
  v_fmac_f32 v150, v25, v146
  v_fmac_f32 v151, v137, v147
  v_cvt_pk_bf16_f32 v184, v148, v149
  v_cvt_pk_bf16_f32 v185, v150, v151
  v_dot2_f32_bf16 v48, v182, v8, v48
  v_dot2_f32_bf16 v50, v182, v182, v50
  v_dot2_f32_bf16 v49, v183, v8, v49
  v_dot2_f32_bf16 v51, v183, v183, v51
  s_waitcnt vmcnt(0)
  v_fma_f32 v26, v26, v57, -v56
  v_fma_f32 v138, v138, v57, -v56
  v_fma_f32 v27, v27, v57, -v56
  v_fma_f32 v139, v139, v57, -v56
  s_waitcnt lgkmcnt(6)
  v_fmac_f32 v156, v26, v152
  v_fmac_f32 v157, v138, v153
  v_fmac_f32 v158, v27, v154
  v_fmac_f32 v159, v139, v155
  v_cvt_pk_bf16_f32 v186, v156, v157
  v_cvt_pk_bf16_f32 v187, v158, v159
  v_dot2_f32_bf16 v48, v184, v8, v48
  v_dot2_f32_bf16 v50, v184, v184, v50
  v_dot2_f32_bf16 v49, v185, v8, v49
  v_dot2_f32_bf16 v51, v185, v185, v51
  ds_write_b128 v61, v[184:187] offset:2048
  v_fma_f32 v28, v28, v57, -v56
  v_fma_f32 v140, v140, v57, -v56
  v_fma_f32 v29, v29, v57, -v56
  v_fma_f32 v141, v141, v57, -v56
  s_waitcnt lgkmcnt(5)
  v_fmac_f32 v164, v28, v160
  v_fmac_f32 v165, v140, v161
  v_fmac_f32 v166, v29, v162
  v_fmac_f32 v167, v141, v163
  v_cvt_pk_bf16_f32 v188, v164, v165
  v_cvt_pk_bf16_f32 v189, v166, v167
  v_dot2_f32_bf16 v48, v186, v8, v48
  v_dot2_f32_bf16 v50, v186, v186, v50
  v_dot2_f32_bf16 v49, v187, v8, v49
  v_dot2_f32_bf16 v51, v187, v187, v51
  v_fma_f32 v30, v30, v57, -v56
  v_fma_f32 v142, v142, v57, -v56
  v_fma_f32 v31, v31, v57, -v56
  v_fma_f32 v143, v143, v57, -v56
  s_waitcnt lgkmcnt(3)
  v_fmac_f32 v172, v30, v168
  v_fmac_f32 v173, v142, v169
  v_fmac_f32 v174, v31, v170
  v_fmac_f32 v175, v143, v171
  v_cvt_pk_bf16_f32 v190, v172, v173
  v_cvt_pk_bf16_f32 v191, v174, v175
  v_dot2_f32_bf16 v48, v188, v8, v48
  v_dot2_f32_bf16 v50, v188, v188, v50
  v_dot2_f32_bf16 v49, v189, v8, v49
  v_dot2_f32_bf16 v51, v189, v189, v51
  ds_write_b128 v61, v[188:191] offset:3072
  v_dot2_f32_bf16 v48, v190, v8, v48
  v_dot2_f32_bf16 v50, v190, v190, v50
  v_dot2_f32_bf16 v49, v191, v8, v49
  v_dot2_f32_bf16 v51, v191, v191, v51
  s_nop 1
  v_add_f32 v48, v48, v49
  v_add_f32 v50, v50, v51
  s_nop 1
  v_permlane32_swap_b32 v48, v50
  v_add_f32 v48, v48, v50
  ds_write_b32 v59, v48 offset:4096
  s_cmp_lt_u32 s3, 4
  s_cbranch_scc1 L_b_s4
  buffer_load_dwordx4 v[96:99], v2, s[8:11], s88 offen offset:0 sc1
  buffer_load_dwordx4 v[100:103], v2, s[8:11], s88 offen offset:1024 sc1
  buffer_load_dwordx4 v[104:107], v2, s[8:11], s88 offen offset:2048 sc1
  buffer_load_dwordx4 v[108:111], v2, s[8:11], s88 offen offset:3072 sc1
L_b_s4:
  s_nop 0
  s_lshl_b32 s6, s79, 14
  v_add_u32 v61, s6, v2
  s_waitcnt lgkmcnt(0)
  s_barrier
  ds_read_b128 v[144:147], v61 offset:0
  ds_read_b128 v[148:151], v61 offset:1024
  ds_read_b128 v[152:155], v61 offset:2048
  ds_read_b128 v[156:159], v61 offset:3072
  ds_read_b128 v[160:163], v61 offset:4096
  ds_read_b128 v[164:167], v61 offset:5120
  ds_read_b128 v[168:171], v61 offset:6144
  ds_read_b128 v[172:175], v61 offset:7168
  v_mfma_f32_32x32x16_bf16 v[32:47], v[224:227], v[8:11], v[32:47]
  v_mfma_f32_32x32x16_bf16 v[32:47], v[228:231], v[8:11], v[32:47]
  v_mfma_f32_32x32x16_bf16 v[32:47], v[232:235], v[8:11], v[32:47]
  v_mfma_f32_32x32x16_bf16 v[32:47], v[236:239], v[8:11], v[32:47]
  v_mfma_f32_32x32x16_bf16 v[32:47], v[240:243], v[8:11], v[32:47]
  v_mfma_f32_32x32x16_bf16 v[32:47], v[244:247], v[8:11], v[32:47]
  v_mfma_f32_32x32x16_bf16 v[32:47], v[248:251], v[8:11], v[32:47]
  v_mfma_f32_32x32x16_bf16 v[32:47], v[252:255], v[8:11], v[32:47]
  s_mov_b32 s5, 2387968
  buffer_load_dword v58, v7, s[8:11], s5 offen sc1
  s_cmp_lg_u32 s84, s58
  s_cbranch_scc1 L_b_sh
  buffer_store_dwordx4 v[176:179], v2, s[8:11], s94 offen offset:0 sc1
  buffer_store_dwordx4 v[180:183], v2, s[8:11], s94 offen offset:1024 sc1
  buffer_store_dwordx4 v[184:187], v2, s[8:11], s94 offen offset:2048 sc1
  buffer_store_dwordx4 v[188:191], v2, s[8:11], s94 offen offset:3072 sc1
L_b_sh:
  s_nop 1
  s_lshl_b32 s6, s3, 11
  s_add_u32 s6, s6, 32768
  v_add_u32 v60, s6, v2
  s_waitcnt lgkmcnt(7)
  v_mfma_f32_32x32x16_bf16 v[16:31], v[192:195], v[144:147], 0
  ds_read_b128 v[144:147], v61 offset:8192
  s_waitcnt lgkmcnt(7)
  v_mfma_f32_32x32x16_bf16 v[16:31], v[196:199], v[148:151], v[16:31]
  ds_read_b128 v[148:151], v61 offset:9216
  s_add_u32 s7, s88, 4096
  buffer_load_dwordx4 v[112:115], v2, s[8:11], s7 offen offset:0 sc1
  s_waitcnt lgkmcnt(7)
  v_mfma_f32_32x32x16_bf16 v[16:31], v[200:203], v[152:155], v[16:31]
  ds_read_b128 v[152:155], v61 offset:10240
  s_waitcnt lgkmcnt(7)
  v_mfma_f32_32x32x16_bf16 v[16:31], v[204:207], v[156:159], v[16:31]
  ds_read_b128 v[156:159], v61 offset:11264
  s_waitcnt lgkmcnt(7)
  v_mfma_f32_32x32x16_bf16 v[16:31], v[208:211], v[160:163], v[16:31]
  ds_read_b128 v[160:163], v61 offset:12288
  s_add_u32 s7, s88, 4096
  buffer_load_dwordx4 v[116:119], v2, s[8:11], s7 offen offset:1024 sc1
  s_waitcnt lgkmcnt(7)
  v_mfma_f32_32x32x16_bf16 v[16:31], v[212:215], v[164:167], v[16:31]
  ds_read_b128 v[164:167], v61 offset:13312
  s_waitcnt lgkmcnt(7)
  v_mfma_f32_32x32x16_bf16 v[16:31], v[216:219], v[168:171], v[16:31]
  ds_read_b128 v[168:171], v61 offset:14336
  s_waitcnt lgkmcnt(7)
  v_mfma_f32_32x32x16_bf16 v[16:31], v[220:223], v[172:175], v[16:31]
  ds_read_b128 v[172:175], v61 offset:15360
  s_add_u32 s7, s88, 4096
  buffer_load_dwordx4 v[120:123], v2, s[8:11], s7 offen offset:2048 sc1
  s_waitcnt lgkmcnt(7)
  v_mfma_f32_32x32x16_bf16 v[16:31], v[224:227], v[144:147], v[16:31]
  ds_read_b128 v[48:51], v13 offset:4096
  ds_read_b128 v[52:55], v13 offset:4112
  s_waitcnt lgkmcnt(1)
  v_add_f32 v48, v48, v49
  v_add_f32 v50, v50, v51
  s_waitcnt lgkmcnt(0)
  v_add_f32 v52, v52, v53
  v_add_f32 v54, v54, v55
  v_add_f32 v48, v48, v50
  v_add_f32 v52, v52, v54
  v_add_f32 v48, v48, v52
  v_mov_b32 v49, v48
  s_nop 1
  v_permlane32_swap_b32 v48, v49
  v_mul_f32 v56, 0x3b000000, v48
  v_mul_f32 v49, 0x3b000000, v49
  v_fma_f32 v49, -v56, v56, v49
  v_max_f32 v49, 0, v49
  v_add_f32 v49, 0x3727c5ac, v49
  v_rsq_f32 v57, v49
  v_sub_f32 v56, 0, v56
  v_rcp_f32 v54, v57
  v_mul_f32 v53, v57, v57
  v_mul_f32 v52, 0xc0135761, v57
  v_mul_f32 v53, v53, v57
  v_mul_f32 v53, 0xbdd2d3e8, v53
  v_mfma_f32_32x32x16_bf16 v[16:31], v[228:231], v[148:151], v[16:31]
  v_mfma_f32_32x32x16_bf16 v[16:31], v[232:235], v[152:155], v[16:31]
  s_add_u32 s7, s88, 4096
  buffer_load_dwordx4 v[124:127], v2, s[8:11], s7 offen offset:3072 sc1
  v_mfma_f32_32x32x16_bf16 v[16:31], v[236:239], v[156:159], v[16:31]
  v_mfma_f32_32x32x16_bf16 v[16:31], v[240:243], v[160:163], v[16:31]
  v_mfma_f32_32x32x16_bf16 v[16:31], v[244:247], v[164:167], v[16:31]
  v_mfma_f32_32x32x16_bf16 v[16:31], v[248:251], v[168:171], v[16:31]
  v_mfma_f32_32x32x16_bf16 v[16:31], v[252:255], v[172:175], v[16:31]
  s_lshl_b32 s6, s57, 5
  s_lshl_b32 s7, s78, 1
  s_add_u32 s6, s6, s7
  s_add_u32 s6, s6, s79
  s_lshl_b32 s6, s6, 10
  s_add_u32 s88, s6, 10616832
  s_add_u32 s88, s88, s96
  s_cmp_lg_u32 s79, 0
  s_cbranch_scc1 L_b_k1
  s_nop 2
  v_fmac_f32 v24, v56, v40
  v_fmac_f32 v25, v56, v41
  v_fmac_f32 v26, v56, v42
  v_fmac_f32 v27, v56, v43
  v_fmac_f32 v28, v56, v44
  v_fmac_f32 v29, v56, v45
  v_fmac_f32 v30, v56, v46
  v_fmac_f32 v31, v56, v47
  ds_write_b128 v60, v[24:27] offset:0
  ds_write_b128 v60, v[28:31] offset:1024
  v_fma_f32 v72, v56, v32, v16
  v_fma_f32 v73, v56, v33, v17
  v_fma_f32 v74, v56, v34, v18
  v_fma_f32 v75, v56, v35, v19
  v_fma_f32 v76, v56, v36, v20
  v_fma_f32 v77, v56, v37, v21
  v_fma_f32 v78, v56, v38, v22
  v_fma_f32 v79, v56, v39, v23
  s_branch L_b_kj
L_b_k1:
  s_nop 4
  v_fmac_f32 v16, v56, v32
  v_fmac_f32 v17, v56, v33
  v_fmac_f32 v18, v56, v34
  v_fmac_f32 v19, v56, v35
  v_fmac_f32 v20, v56, v36
  v_fmac_f32 v21, v56, v37
  v_fmac_f32 v22, v56, v38
  v_fmac_f32 v23, v56, v39
  ds_write_b128 v60, v[16:19] offset:0
  ds_write_b128 v60, v[20:23] offset:1024
  v_fma_f32 v72, v56, v40, v24
  v_fma_f32 v73, v56, v41, v25
  v_fma_f32 v74, v56, v42, v26
  v_fma_f32 v75, v56, v43, v27
  v_fma_f32 v76, v56, v44, v28
  v_fma_f32 v77, v56, v45, v29
  v_fma_f32 v78, v56, v46, v30
  v_fma_f32 v79, v56, v47, v31
L_b_kj:
  v_xor_b32 v60, 8192, v60
  s_waitcnt lgkmcnt(0)
  s_waitcnt vmcnt(4)
  v_cmp_ne_u32 vcc, s56, v58
  s_cbranch_vccz L_polld3
  s_mov_b32 s5, 2387968
  s_mov_b32 s6, 0
L_poll3:
  buffer_load_dword v58, v7, s[8:11], s5 offen sc1
  s_add_u32 s6, s6, 1
  s_waitcnt vmcnt(0)
  v_cmp_ne_u32 vcc, s56, v58
  s_cbranch_vccz L_polld3
  s_sleep 1
  s_cmp_lt_u32 s6, 0x40000
  s_cbranch_scc1 L_poll3
L_polld3:
  s_barrier
  ds_read_b128 v[16:19], v60 offset:0
  ds_read_b128 v[20:23], v60 offset:1024
  s_waitcnt lgkmcnt(1)
  v_add_f32 v72, v72, v16
  v_add_f32 v73, v73, v17
  v_add_f32 v74, v74, v18
  v_add_f32 v75, v75, v19
  s_waitcnt lgkmcnt(0)
  v_add_f32 v76, v76, v20
  v_add_f32 v77, v77, v21
  v_add_f32 v78, v78, v22
  v_add_f32 v79, v79, v23
  v_mul_f32 v40, v72, v72
  v_mul_f32 v41, v73, v73
  v_mul_f32 v42, v74, v74
  v_mul_f32 v43, v75, v75
  v_mul_f32 v44, v76, v76
  v_mul_f32 v45, v77, v77
  v_mul_f32 v46, v78, v78
  v_mul_f32 v47, v79, v79
  v_fma_f32 v40, v40, v53, v52
  v_fma_f32 v41, v41, v53, v52
  v_fma_f32 v42, v42, v53, v52
  v_fma_f32 v43, v43, v53, v52
  v_fma_f32 v44, v44, v53, v52
  v_fma_f32 v45, v45, v53, v52
  v_fma_f32 v46, v46, v53, v52
  v_fma_f32 v47, v47, v53, v52
  v_mul_f32 v40, v40, v72
  v_mul_f32 v41, v41, v73
  v_mul_f32 v42, v42, v74
  v_mul_f32 v43, v43, v75
  v_mul_f32 v44, v44, v76
  v_mul_f32 v45, v45, v77
  v_mul_f32 v46, v46, v78
  v_mul_f32 v47, v47, v79
  v_exp_f32 v40, v40
  v_exp_f32 v41, v41
  v_exp_f32 v42, v42
  v_exp_f32 v43, v43
  v_exp_f32 v44, v44
  v_exp_f32 v45, v45
  v_exp_f32 v46, v46
  v_exp_f32 v47, v47
  v_fma_f32 v40, v40, v54, v54
  v_fma_f32 v41, v41, v54, v54
  v_fma_f32 v42, v42, v54, v54
  v_fma_f32 v43, v43, v54, v54
  v_fma_f32 v44, v44, v54, v54
  v_fma_f32 v45, v45, v54, v54
  v_fma_f32 v46, v46, v54, v54
  v_fma_f32 v47, v47, v54, v54
  v_rcp_f32 v40, v40
  v_rcp_f32 v41, v41
  v_rcp_f32 v42, v42
  v_rcp_f32 v43, v43
  v_rcp_f32 v44, v44
  v_rcp_f32 v45, v45
  v_rcp_f32 v46, v46
  v_rcp_f32 v47, v47
  v_mul_f32 v72, v72, v40
  v_mul_f32 v73, v73, v41
  v_mul_f32 v74, v74, v42
  v_mul_f32 v75, v75, v43
  v_mul_f32 v76, v76, v44
  v_mul_f32 v77, v77, v45
  v_mul_f32 v78, v78, v46
  v_mul_f32 v79, v79, v47
  v_cvt_pk_bf16_f32 v32, v72, v73
  v_cvt_pk_bf16_f32 v33, v74, v75
  v_cvt_pk_bf16_f32 v34, v76, v77
  v_cvt_pk_bf16_f32 v35, v78, v79
  buffer_store_dwordx4 v[32:35], v2, s[8:11], s88 offen sc1
  s_add_u32 s7, s82, 8192
  buffer_load_dwordx4 v[128:131], v2, s[8:11], s7 offen offset:0 sc1
  s_add_u32 s7, s82, 8192
  buffer_load_dwordx4 v[132:135], v2, s[8:11], s7 offen offset:1024 sc1
  s_add_u32 s7, s82, 8192
  buffer_load_dwordx4 v[136:139], v2, s[8:11], s7 offen offset:2048 sc1
  s_add_u32 s7, s82, 8192
  buffer_load_dwordx4 v[140:143], v2, s[8:11], s7 offen offset:3072 sc1
  s_lshr_b32 s6, s84, 1
  s_add_u32 s6, s6, 1
  s_sub_u32 s7, 0, s6
  s_bitcmp0_b32 s84, 0
  s_cselect_b32 s6, s7, s6
  s_lshl_b32 s7, s59, 6
  s_add_u32 s6, s6, s7
  v_mov_b32 v7, 2146435072
  v_add_u32 v5, s6, v3
  v_lshrrev_b32 v6, 5, v5
  v_lshlrev_b32 v6, 15, v6
  v_and_b32 v13, 31, v5
  v_lshl_add_u32 v13, v4, 5, v13
  v_lshl_add_u32 v6, v13, 4, v6
  v_lshrrev_b32 v13, 6, v5
  v_mul_u32_u24 v13, 0x70000, v13
  v_add_u32 v6, v6, v13
  v_cmp_gt_u32 vcc, 2048, v5
  s_nop 1
  v_cndmask_b32 v252, v7, v6, vcc
  v_add_u32 v5, s6, v3
  v_add_u32 v5, 32, v5
  v_lshrrev_b32 v6, 5, v5
  v_lshlrev_b32 v6, 15, v6
  v_and_b32 v13, 31, v5
  v_lshl_add_u32 v13, v4, 5, v13
  v_lshl_add_u32 v6, v13, 4, v6
  v_lshrrev_b32 v13, 6, v5
  v_mul_u32_u24 v13, 0x70000, v13
  v_add_u32 v6, v6, v13
  v_cmp_gt_u32 vcc, 2048, v5
  s_nop 1
  v_cndmask_b32 v253, v7, v6, vcc
  s_lshl_b32 s88, s59, 1
  s_lshr_b32 s7, s84, 1
  s_add_u32 s88, s88, s7
  s_lshl_b32 s89, s85, 1
  s_and_b32 s7, s84, 1
  s_add_u32 s89, s89, s7
  s_lshl_b32 s6, s88, 5
  s_add_u32 s6, s6, s89
  s_lshl_b32 s90, s6, 10
  s_lshl_b32 s91, s3, 12
  s_add_u32 s92, s91, 10616832
  s_lshl_b32 s6, s84, 13
  v_add_u32 v13, s6, v2
  v_and_b32 v6, 15, v1
  s_lshl_b32 s6, s59, 3
  s_sub_u32 s6, s6, 4
  v_add_u32 v254, s6, v6
  v_max_i32 v254, 0, v254
  v_min_i32 v254, 0xff, v254
  v_lshlrev_b32 v254, 4, v254
  v_lshlrev_b32 v233, 4, v6
  s_lshl_b32 s6, s3, 6
  s_add_u32 s6, s6, 162048
  v_lshl_add_u32 v232, v6, 2, s6
  s_mul_i32 s6, s85, 112
  s_mul_i32 s7, s84, 28
  s_add_u32 s6, s6, s7
  s_lshl_b32 s6, s6, 10
  s_add_u32 s86, s6, 6291456
  s_waitcnt vmcnt(4)
  s_waitcnt lgkmcnt(0)
  s_barrier
  s_lshl_b32 s4, s61, 4
  s_add_u32 s4, s4, 2424832
  s_cmp_lg_u32 s3, 0
  s_cselect_b32 s4, 2146435072, s4
  v_mov_b32 v5, s56
  buffer_store_dword v5, v14, s[8:11], s4 offen sc1
  s_add_u32 s7, s82, 12288
  buffer_load_dwordx4 v[144:147], v2, s[8:11], s7 offen offset:0 sc1
  s_add_u32 s7, s82, 12288
  buffer_load_dwordx4 v[148:151], v2, s[8:11], s7 offen offset:1024 sc1
  s_add_u32 s7, s82, 12288
  buffer_load_dwordx4 v[152:155], v2, s[8:11], s7 offen offset:2048 sc1
  s_add_u32 s7, s82, 12288
  buffer_load_dwordx4 v[156:159], v2, s[8:11], s7 offen offset:3072 sc1
  s_add_u32 s7, s82, 16384
  buffer_load_dwordx4 v[160:163], v2, s[8:11], s7 offen offset:0 sc1
  s_add_u32 s7, s82, 16384
  buffer_load_dwordx4 v[164:167], v2, s[8:11], s7 offen offset:1024 sc1
  s_add_u32 s7, s82, 16384
  buffer_load_dwordx4 v[168:171], v2, s[8:11], s7 offen offset:2048 sc1
  s_add_u32 s7, s82, 16384
  buffer_load_dwordx4 v[172:175], v2, s[8:11], s7 offen offset:3072 sc1
  s_add_u32 s7, s82, 20480
  buffer_load_dwordx4 v[176:179], v2, s[8:11], s7 offen offset:0 sc1
  s_add_u32 s7, s82, 20480
  buffer_load_dwordx4 v[180:183], v2, s[8:11], s7 offen offset:1024 sc1
  s_add_u32 s7, s82, 20480
  buffer_load_dwordx4 v[184:187], v2, s[8:11], s7 offen offset:2048 sc1
  s_add_u32 s7, s82, 20480
  buffer_load_dwordx4 v[188:191], v2, s[8:11], s7 offen offset:3072 sc1
  s_cmp_lg_u32 s3, 7
  s_cbranch_scc1 L_c_nw
  s_waitcnt vmcnt(0)
L_c_nw:
  s_mov_b32 s5, 2424832
  s_mov_b32 s6, 0
  s_cmp_lg_u32 s3, 7
  s_cbranch_scc1 L_polld4
L_poll4:
  buffer_load_dword v6, v254, s[8:11], s5 offen sc1
  s_add_u32 s6, s6, 1
  s_waitcnt vmcnt(0)
  v_cmp_ne_u32 vcc, s56, v6
  s_cbranch_vccz L_polld4
  s_sleep 2
  s_cmp_lt_u32 s6, 0x40000
  s_cbranch_scc1 L_poll4
L_polld4:
  s_barrier
  s_add_u32 m0, s91, 0
  s_nop 0
  buffer_load_dwordx4 v252, s[8:11], s92 offen offset:0 sc1 lds
  buffer_load_dwordx4 v252, s[8:11], s92 offen offset:1024 sc1 lds
  buffer_load_dwordx4 v252, s[8:11], s92 offen offset:2048 sc1 lds
  buffer_load_dwordx4 v252, s[8:11], s92 offen offset:3072 sc1 lds
  s_barrier
  s_add_u32 m0, s91, 32768
  s_nop 0
  buffer_load_dwordx4 v253, s[8:11], s92 offen offset:0 sc1 lds
  buffer_load_dwordx4 v253, s[8:11], s92 offen offset:1024 sc1 lds
  buffer_load_dwordx4 v253, s[8:11], s92 offen offset:2048 sc1 lds
  buffer_load_dwordx4 v253, s[8:11], s92 offen offset:3072 sc1 lds
  s_add_u32 s6, s90, 10551296
  s_add_u32 s6, s6, s96
  buffer_load_dwordx4 v[224:227], v2, s[8:11], s6 offen sc1
  s_lshl_b32 s6, s89, 8
  s_add_u32 s7, s6, 2138112
  buffer_load_dwordx4 v[60:63], v233, s[8:11], s7 offen sc1
  v_mov_b32 v9, v232
  s_lshl_b32 s6, s3, 13
  s_add_u32 s6, s6, 65536
  v_add_u32 v7, s6, v2
  s_waitcnt vmcnt(6)
  s_barrier
  ds_read_b128 v[228:231], v13 offset:0
  ds_read_b128 v[232:235], v13 offset:1024
  ds_read_b128 v[236:239], v13 offset:2048
  ds_read_b128 v[240:243], v13 offset:3072
  ds_read_b128 v[244:247], v13 offset:4096
  ds_read_b128 v[248:251], v13 offset:5120
  ds_read_b128 v[252:255], v13 offset:6144
  s_waitcnt lgkmcnt(6)
  v_mfma_f32_32x32x16_bf16 v[16:31], v[96:99], v[228:231], 0
  ds_read_b128 v[228:231], v13 offset:7168
  s_waitcnt lgkmcnt(6)
  v_mfma_f32_32x32x16_bf16 v[16:31], v[100:103], v[232:235], v[16:31]
  s_waitcnt lgkmcnt(5)
  v_mfma_f32_32x32x16_bf16 v[16:31], v[104:107], v[236:239], v[16:31]
  s_waitcnt lgkmcnt(4)
  v_mfma_f32_32x32x16_bf16 v[16:31], v[108:111], v[240:243], v[16:31]
  s_waitcnt lgkmcnt(3)
  v_mfma_f32_32x32x16_bf16 v[16:31], v[112:115], v[244:247], v[16:31]
  s_waitcnt lgkmcnt(2)
  v_mfma_f32_32x32x16_bf16 v[16:31], v[116:119], v[248:251], v[16:31]
  s_waitcnt lgkmcnt(1)
  v_mfma_f32_32x32x16_bf16 v[16:31], v[120:123], v[252:255], v[16:31]
  s_waitcnt lgkmcnt(0)
  v_mfma_f32_32x32x16_bf16 v[16:31], v[124:127], v[228:231], v[16:31]
  s_waitcnt vmcnt(0)
  s_barrier
  ds_read_b128 v[232:235], v13 offset:32768
  ds_read_b128 v[236:239], v13 offset:33792
  ds_read_b128 v[240:243], v13 offset:34816
  ds_read_b128 v[244:247], v13 offset:35840
  ds_read_b128 v[248:251], v13 offset:36864
  ds_read_b128 v[252:255], v13 offset:37888
  ds_read_b128 v[228:231], v13 offset:38912
  v_add_f32 v60, v60, v61
  v_add_f32 v62, v62, v63
  v_add_f32 v60, v60, v62
  v_cvt_pk_bf16_f32 v60, v60, v60
  v_and_b32 v60, 0xffff0000, v60
  ds_write_b32 v9, v60
  s_waitcnt lgkmcnt(7)
  v_mfma_f32_32x32x16_bf16 v[32:47], v[96:99], v[232:235], 0
  ds_read_b128 v[232:235], v13 offset:39936
  buffer_load_dwordx4 v[64:67], v2, s[8:11], s82 offen offset:0 sc1
  s_waitcnt lgkmcnt(7)
  v_mfma_f32_32x32x16_bf16 v[32:47], v[100:103], v[236:239], v[32:47]
  buffer_load_dwordx4 v[68:71], v2, s[8:11], s82 offen offset:1024 sc1
  s_waitcnt lgkmcnt(6)
  v_mfma_f32_32x32x16_bf16 v[32:47], v[104:107], v[240:243], v[32:47]
  buffer_load_dwordx4 v[72:75], v2, s[8:11], s82 offen offset:2048 sc1
  s_waitcnt lgkmcnt(0)
  s_cmp_eq_u32 s84, 0
  s_cbranch_scc1 L_c_own0
  ds_write_b128 v7, v[16:19] offset:0
  ds_write_b128 v7, v[20:23] offset:1024
  s_branch L_c_pj0
L_c_own0:
  v_mov_b32 v48, v16
  v_mov_b32 v49, v17
  v_mov_b32 v50, v18
  v_mov_b32 v51, v19
  v_mov_b32 v52, v20
  v_mov_b32 v53, v21
  v_mov_b32 v54, v22
  v_mov_b32 v55, v23
L_c_pj0:
  s_cmp_eq_u32 s84, 1
  s_cbranch_scc1 L_c_own1
  ds_write_b128 v7, v[24:27] offset:2048
  ds_write_b128 v7, v[28:31] offset:3072
  s_branch L_c_pj1
L_c_own1:
  v_mov_b32 v48, v24
  v_mov_b32 v49, v25
  v_mov_b32 v50, v26
  v_mov_b32 v51, v27
  v_mov_b32 v52, v28
  v_mov_b32 v53, v29
  v_mov_b32 v54, v30
  v_mov_b32 v55, v31
L_c_pj1:
  v_mfma_f32_32x32x16_bf16 v[32:47], v[108:111], v[244:247], v[32:47]
  buffer_load_dwordx4 v[76:79], v2, s[8:11], s82 offen offset:3072 sc1
  v_mfma_f32_32x32x16_bf16 v[32:47], v[112:115], v[248:251], v[32:47]
  s_add_u32 s7, s82, 4096
  buffer_load_dwordx4 v[80:83], v2, s[8:11], s7 offen offset:0 sc1
  v_mfma_f32_32x32x16_bf16 v[32:47], v[116:119], v[252:255], v[32:47]
  s_add_u32 s7, s82, 4096
  buffer_load_dwordx4 v[84:87], v2, s[8:11], s7 offen offset:1024 sc1
  v_mfma_f32_32x32x16_bf16 v[32:47], v[120:123], v[228:231], v[32:47]
  s_add_u32 s7, s82, 4096
  buffer_load_dwordx4 v[88:91], v2, s[8:11], s7 offen offset:2048 sc1
  v_mfma_f32_32x32x16_bf16 v[32:47], v[124:127], v[232:235], v[32:47]
  v_lshlrev_b32 v56, 16, v224
  v_and_b32 v57, 0xffff0000, v224
  v_lshlrev_b32 v58, 16, v225
  v_and_b32 v59, 0xffff0000, v225
  v_lshlrev_b32 v60, 16, v226
  v_and_b32 v61, 0xffff0000, v226
  v_lshlrev_b32 v62, 16, v227
  v_and_b32 v63, 0xffff0000, v227
  s_nop 3
  s_cmp_eq_u32 s84, 2
  s_cbranch_scc1 L_c_own2
  ds_write_b128 v7, v[32:35] offset:4096
  ds_write_b128 v7, v[36:39] offset:5120
  s_branch L_c_pj2
L_c_own2:
  v_mov_b32 v48, v32
  v_mov_b32 v49, v33
  v_mov_b32 v50, v34
  v_mov_b32 v51, v35
  v_mov_b32 v52, v36
  v_mov_b32 v53, v37
  v_mov_b32 v54, v38
  v_mov_b32 v55, v39
L_c_pj2:
  s_cmp_eq_u32 s84, 3
  s_cbranch_scc1 L_c_own3
  ds_write_b128 v7, v[40:43] offset:6144
  ds_write_b128 v7, v[44:47] offset:7168
  s_branch L_c_pj3
L_c_own3:
  v_mov_b32 v48, v40
  v_mov_b32 v49, v41
  v_mov_b32 v50, v42
  v_mov_b32 v51, v43
  v_mov_b32 v52, v44
  v_mov_b32 v53, v45
  v_mov_b32 v54, v46
  v_mov_b32 v55, v47
L_c_pj3:
  s_lshl_b32 s6, s83, 13
  s_lshl_b32 s7, s84, 11
  s_add_u32 s6, s6, s7
  s_add_u32 s6, s6, 65536
  v_add_u32 v7, s6, v2
  s_lshl_b32 s6, s84, 14
  v_add_u32 v7, s6, v7
  v_xor_b32 v229, 16384, v7
  v_xor_b32 v230, 32768, v7
  v_xor_b32 v231, 49152, v7
  s_add_u32 s91, s90, 8388608
  v_add_f32 v48, v48, v56
  v_add_f32 v49, v49, v57
  v_add_f32 v50, v50, v58
  v_add_f32 v51, v51, v59
  v_add_f32 v52, v52, v60
  v_add_f32 v53, v53, v61
  v_add_f32 v54, v54, v62
  v_add_f32 v55, v55, v63
  s_waitcnt lgkmcnt(0)
  s_barrier
  ds_read_b128 v[24:27], v229 offset:0
  ds_read_b128 v[28:31], v229 offset:1024
  ds_read_b128 v[32:35], v230 offset:0
  ds_read_b128 v[36:39], v230 offset:1024
  ds_read_b128 v[40:43], v231 offset:0
  ds_read_b128 v[44:47], v231 offset:1024
  s_waitcnt lgkmcnt(5)
  v_add_f32 v48, v48, v24
  v_add_f32 v49, v49, v25
  v_add_f32 v50, v50, v26
  v_add_f32 v51, v51, v27
  s_waitcnt lgkmcnt(4)
  v_add_f32 v52, v52, v28
  v_add_f32 v53, v53, v29
  v_add_f32 v54, v54, v30
  v_add_f32 v55, v55, v31
  s_waitcnt lgkmcnt(1)
  v_add_f32 v32, v32, v40
  v_add_f32 v33, v33, v41
  v_add_f32 v34, v34, v42
  v_add_f32 v35, v35, v43
  s_waitcnt lgkmcnt(0)
  v_add_f32 v36, v36, v44
  v_add_f32 v37, v37, v45
  v_add_f32 v38, v38, v46
  v_add_f32 v39, v39, v47
  v_add_f32 v48, v48, v32
  v_add_f32 v49, v49, v33
  v_add_f32 v50, v50, v34
  v_add_f32 v51, v51, v35
  v_add_f32 v52, v52, v36
  v_add_f32 v53, v53, v37
  v_add_f32 v54, v54, v38
  v_add_f32 v55, v55, v39
  v_cvt_pk_bf16_f32 v240, v48, v49
  v_cvt_pk_bf16_f32 v241, v50, v51
  v_cvt_pk_bf16_f32 v242, v52, v53
  v_cvt_pk_bf16_f32 v243, v54, v55
  s_cmp_lg_u32 s87, 0
  s_cbranch_scc1 L_dp4
  buffer_store_dwordx4 v[240:243], v2, s[8:11], s91 offen sc1
  s_branch L_dj4
L_dp4:
  buffer_store_dwordx4 v[240:243], v2, s[8:11], s91 offen
L_dj4:
  v_mov_b32 v16, 0
  v_mov_b32 v17, 0
  v_mov_b32 v18, 0
  v_mov_b32 v19, 0
  v_dot2_f32_bf16 v16, v240, v8, v16
  v_dot2_f32_bf16 v18, v240, v240, v18
  v_dot2_f32_bf16 v17, v241, v8, v17
  v_dot2_f32_bf16 v19, v241, v241, v19
  v_dot2_f32_bf16 v16, v242, v8, v16
  v_dot2_f32_bf16 v18, v242, v242, v18
  v_dot2_f32_bf16 v17, v243, v8, v17
  v_dot2_f32_bf16 v19, v243, v243, v19
  s_nop 1
  v_add_f32 v16, v16, v17
  v_add_f32 v18, v18, v19
  s_nop 1
  v_permlane32_swap_b32 v16, v18
  v_add_f32 v16, v16, v18
  s_and_b32 s6, s90, 0xffff
  s_lshr_b32 s6, s6, 2
  s_lshl_b32 s7, s59, 16
  s_add_u32 s6, s6, s7
  s_add_u32 s6, s6, 49152
  v_lshlrev_b32 v7, 2, v1
  s_cmp_lg_u32 s87, 0
  s_cbranch_scc1 L_dp5
  buffer_store_dword v16, v7, s[8:11], s6 offen sc1
  s_branch L_dj5
L_dp5:
  buffer_store_dword v16, v7, s[8:11], s6 offen
L_dj5:
  v_lshlrev_b32 v7, 4, v0
  v_add_u32 v7, 147456, v7
  ds_write_b128 v7, v[240:243]
  s_add_u32 s7, s82, 4096
  buffer_load_dwordx4 v[92:95], v2, s[8:11], s7 offen offset:3072 sc1
  s_add_u32 s7, s82, 24576
  buffer_load_dwordx4 v[192:195], v2, s[8:11], s7 offen offset:0 sc1
  s_add_u32 s7, s82, 24576
  buffer_load_dwordx4 v[196:199], v2, s[8:11], s7 offen offset:1024 sc1
  s_add_u32 s7, s82, 24576
  buffer_load_dwordx4 v[200:203], v2, s[8:11], s7 offen offset:2048 sc1
  v_and_b32 v5, 7, v1
  s_lshl_b32 s6, s59, 3
  v_add_u32 v5, s6, v5
  v_lshlrev_b32 v254, 4, v5
  s_lshl_b32 s6, s59, 16
  s_lshl_b32 s92, s3, 10
  s_add_u32 s6, s6, s92
  s_add_u32 s91, s6, 8388608
  v_add_u32 v7, 81920, v2
  v_lshlrev_b32 v13, 5, v1
  v_add_u32 v13, 155648, v13
  s_mul_i32 s95, s3, 0
  s_mul_i32 s6, s59, 512
  s_lshl_b32 s7, s81, 1
  s_add_u32 s6, s6, s7
  s_lshl_b32 s6, s6, 10
  s_add_u32 s93, s6, 10682368
  s_lshl_b32 s6, s59, 16
  s_lshl_b32 s7, s81, 11
  s_add_u32 s6, s6, s7
  s_add_u32 s94, s6, 10551296
  s_add_u32 s94, s94, s96
  s_add_u32 s6, s6, 4294901760
  s_cmp_ge_u32 s81, 32
  s_cselect_b32 s94, s6, s94
  s_waitcnt vmcnt(4)
  s_waitcnt lgkmcnt(0)
  s_barrier
  s_lshl_b32 s4, s61, 4
  s_add_u32 s4, s4, 2375680
  s_cmp_lg_u32 s3, 0
  s_cselect_b32 s4, 2146435072, s4
  v_mov_b32 v5, s56
  s_cmp_lg_u32 s87, 0
  s_cbranch_scc1 L_dp6
  buffer_store_dword v5, v14, s[8:11], s4 offen sc1
  s_branch L_dj6
L_dp6:
  buffer_store_dword v5, v14, s[8:11], s4 offen
L_dj6:
  s_cmp_eq_u32 s60, 7
  s_cbranch_scc1 L_d_skip
  s_cmp_eq_u32 s3, 1
  s_cbranch_scc1 L_d_pl
  s_add_u32 s7, s82, 24576
  buffer_load_dwordx4 v[204:207], v2, s[8:11], s7 offen offset:3072 sc1
  s_add_u32 s7, s82, 28672
  buffer_load_dwordx4 v[208:211], v2, s[8:11], s7 offen offset:0 sc1
  s_add_u32 s7, s82, 28672
  buffer_load_dwordx4 v[212:215], v2, s[8:11], s7 offen offset:1024 sc1
  s_add_u32 s7, s82, 28672
  buffer_load_dwordx4 v[216:219], v2, s[8:11], s7 offen offset:2048 sc1
  s_add_u32 s7, s82, 28672
  buffer_load_dwordx4 v[220:223], v2, s[8:11], s7 offen offset:3072 sc1
L_d_pl:
  v_mov_b32 v9, 0
  v_mov_b32 v10, 0
  v_dot2_f32_bf16 v9, v128, v8, v9
  v_dot2_f32_bf16 v10, v129, v8, v10
  v_dot2_f32_bf16 v9, v130, v8, v9
  v_dot2_f32_bf16 v10, v131, v8, v10
  v_dot2_f32_bf16 v9, v132, v8, v9
  v_dot2_f32_bf16 v10, v133, v8, v10
  v_dot2_f32_bf16 v9, v134, v8, v9
  v_dot2_f32_bf16 v10, v135, v8, v10
  v_dot2_f32_bf16 v9, v136, v8, v9
  v_dot2_f32_bf16 v10, v137, v8, v10
  v_dot2_f32_bf16 v9, v138, v8, v9
  v_dot2_f32_bf16 v10, v139, v8, v10
  v_dot2_f32_bf16 v9, v140, v8, v9
  v_dot2_f32_bf16 v10, v141, v8, v10
  v_dot2_f32_bf16 v9, v142, v8, v9
  v_dot2_f32_bf16 v10, v143, v8, v10
  v_dot2_f32_bf16 v9, v144, v8, v9
  v_dot2_f32_bf16 v10, v145, v8, v10
  v_dot2_f32_bf16 v9, v146, v8, v9
  v_dot2_f32_bf16 v10, v147, v8, v10
  v_dot2_f32_bf16 v9, v148, v8, v9
  v_dot2_f32_bf16 v10, v149, v8, v10
  v_dot2_f32_bf16 v9, v150, v8, v9
  v_dot2_f32_bf16 v10, v151, v8, v10
  v_dot2_f32_bf16 v9, v152, v8, v9
  v_dot2_f32_bf16 v10, v153, v8, v10
  v_dot2_f32_bf16 v9, v154, v8, v9
  v_dot2_f32_bf16 v10, v155, v8, v10
  v_dot2_f32_bf16 v9, v156, v8, v9
  v_dot2_f32_bf16 v10, v157, v8, v10
  v_dot2_f32_bf16 v9, v158, v8, v9
  v_dot2_f32_bf16 v10, v159, v8, v10
  v_dot2_f32_bf16 v9, v160, v8, v9
  v_dot2_f32_bf16 v10, v161, v8, v10
  v_dot2_f32_bf16 v9, v162, v8, v9
  v_dot2_f32_bf16 v10, v163, v8, v10
  v_dot2_f32_bf16 v9, v164, v8, v9
  v_dot2_f32_bf16 v10, v165, v8, v10
  v_dot2_f32_bf16 v9, v166, v8, v9
  v_dot2_f32_bf16 v10, v167, v8, v10
  v_dot2_f32_bf16 v9, v168, v8, v9
  v_dot2_f32_bf16 v10, v169, v8, v10
  v_dot2_f32_bf16 v9, v170, v8, v9
  v_dot2_f32_bf16 v10, v171, v8, v10
  v_dot2_f32_bf16 v9, v172, v8, v9
  v_dot2_f32_bf16 v10, v173, v8, v10
  v_dot2_f32_bf16 v9, v174, v8, v9
  v_dot2_f32_bf16 v10, v175, v8, v10
  v_dot2_f32_bf16 v9, v176, v8, v9
  v_dot2_f32_bf16 v10, v177, v8, v10
  v_dot2_f32_bf16 v9, v178, v8, v9
  v_dot2_f32_bf16 v10, v179, v8, v10
  v_dot2_f32_bf16 v9, v180, v8, v9
  v_dot2_f32_bf16 v10, v181, v8, v10
  v_dot2_f32_bf16 v9, v182, v8, v9
  v_dot2_f32_bf16 v10, v183, v8, v10
  v_dot2_f32_bf16 v9, v184, v8, v9
  v_dot2_f32_bf16 v10, v185, v8, v10
  v_dot2_f32_bf16 v9, v186, v8, v9
  v_dot2_f32_bf16 v10, v187, v8, v10
  v_dot2_f32_bf16 v9, v188, v8, v9
  v_dot2_f32_bf16 v10, v189, v8, v10
  v_dot2_f32_bf16 v9, v190, v8, v9
  v_dot2_f32_bf16 v10, v191, v8, v10
  v_dot2_f32_bf16 v9, v64, v8, v9
  v_dot2_f32_bf16 v10, v65, v8, v10
  v_dot2_f32_bf16 v9, v66, v8, v9
  v_dot2_f32_bf16 v10, v67, v8, v10
  v_dot2_f32_bf16 v9, v68, v8, v9
  v_dot2_f32_bf16 v10, v69, v8, v10
  v_dot2_f32_bf16 v9, v70, v8, v9
  v_dot2_f32_bf16 v10, v71, v8, v10
  v_dot2_f32_bf16 v9, v72, v8, v9
  v_dot2_f32_bf16 v10, v73, v8, v10
  v_dot2_f32_bf16 v9, v74, v8, v9
  v_dot2_f32_bf16 v10, v75, v8, v10
  v_dot2_f32_bf16 v9, v76, v8, v9
  v_dot2_f32_bf16 v10, v77, v8, v10
  v_dot2_f32_bf16 v9, v78, v8, v9
  v_dot2_f32_bf16 v10, v79, v8, v10
  v_dot2_f32_bf16 v9, v80, v8, v9
  v_dot2_f32_bf16 v10, v81, v8, v10
  v_dot2_f32_bf16 v9, v82, v8, v9
  v_dot2_f32_bf16 v10, v83, v8, v10
  v_dot2_f32_bf16 v9, v84, v8, v9
  v_dot2_f32_bf16 v10, v85, v8, v10
  v_dot2_f32_bf16 v9, v86, v8, v9
  v_dot2_f32_bf16 v10, v87, v8, v10
  v_dot2_f32_bf16 v9, v88, v8, v9
  v_dot2_f32_bf16 v10, v89, v8, v10
  v_dot2_f32_bf16 v9, v90, v8, v9
  v_dot2_f32_bf16 v10, v91, v8, v10
  s_lshl_b32 s6, s59, 16
  s_add_u32 s6, s6, s92
  s_add_u32 s71, s6, 49152
  v_lshlrev_b32 v11, 2, v1
  s_mov_b32 s5, 2375680
  s_mov_b32 s6, 0
  s_cmp_lg_u32 s3, 1
  s_cbranch_scc1 L_polld5
L_poll5:
  buffer_load_dword v6, v254, s[8:11], s5 offen sc1
  s_add_u32 s6, s6, 1
  s_waitcnt vmcnt(0)
  v_cmp_ne_u32 vcc, s56, v6
  s_cbranch_vccz L_polld5
  s_sleep 1
  s_cmp_lt_u32 s6, 0x40000
  s_cbranch_scc1 L_poll5
L_polld5:
  s_barrier
  s_cmp_lg_u32 s3, 1
  s_cbranch_scc1 L_d_pl2
  s_add_u32 s7, s82, 24576
  buffer_load_dwordx4 v[204:207], v2, s[8:11], s7 offen offset:3072 sc1
  s_add_u32 s7, s82, 28672
  buffer_load_dwordx4 v[208:211], v2, s[8:11], s7 offen offset:0 sc1
  s_add_u32 s7, s82, 28672
  buffer_load_dwordx4 v[212:215], v2, s[8:11], s7 offen offset:1024 sc1
  s_add_u32 s7, s82, 28672
  buffer_load_dwordx4 v[216:219], v2, s[8:11], s7 offen offset:2048 sc1
  s_add_u32 s7, s82, 28672
  buffer_load_dwordx4 v[220:223], v2, s[8:11], s7 offen offset:3072 sc1
L_d_pl2:
  s_add_u32 m0, s92, 81920
  s_nop 0
  buffer_load_dwordx4 v2, s[8:11], s91 offen offset:0 sc1 lds
  s_add_u32 s6, s91, 8192
  s_add_u32 m0, s92, 90112
  s_nop 0
  buffer_load_dwordx4 v2, s[8:11], s6 offen offset:0 sc1 lds
  s_add_u32 s6, s91, 16384
  s_add_u32 m0, s92, 98304
  s_nop 0
  buffer_load_dwordx4 v2, s[8:11], s6 offen offset:0 sc1 lds
  s_waitcnt vmcnt(3)
  s_mov_b32 s95, s71
  s_lshl_b32 s6, s3, 7
  s_add_u32 s71, s6, 162816
  v_dot2_f32_bf16 v9, v92, v8, v9
  v_dot2_f32_bf16 v10, v93, v8, v10
  v_dot2_f32_bf16 v9, v94, v8, v9
  v_dot2_f32_bf16 v10, v95, v8, v10
  v_dot2_f32_bf16 v9, v192, v8, v9
  v_dot2_f32_bf16 v10, v193, v8, v10
  v_dot2_f32_bf16 v9, v194, v8, v9
  v_dot2_f32_bf16 v10, v195, v8, v10
  v_dot2_f32_bf16 v9, v196, v8, v9
  v_dot2_f32_bf16 v10, v197, v8, v10
  v_dot2_f32_bf16 v9, v198, v8, v9
  v_dot2_f32_bf16 v10, v199, v8, v10
  v_dot2_f32_bf16 v9, v200, v8, v9
  v_dot2_f32_bf16 v10, v201, v8, v10
  v_dot2_f32_bf16 v9, v202, v8, v9
  v_dot2_f32_bf16 v10, v203, v8, v10
  v_dot2_f32_bf16 v9, v204, v8, v9
  v_dot2_f32_bf16 v10, v205, v8, v10
  v_dot2_f32_bf16 v9, v206, v8, v9
  v_dot2_f32_bf16 v10, v207, v8, v10
  v_dot2_f32_bf16 v9, v208, v8, v9
  v_dot2_f32_bf16 v10, v209, v8, v10
  v_dot2_f32_bf16 v9, v210, v8, v9
  v_dot2_f32_bf16 v10, v211, v8, v10
  v_dot2_f32_bf16 v9, v212, v8, v9
  v_dot2_f32_bf16 v10, v213, v8, v10
  v_dot2_f32_bf16 v9, v214, v8, v9
  v_dot2_f32_bf16 v10, v215, v8, v10
  v_dot2_f32_bf16 v9, v216, v8, v9
  v_dot2_f32_bf16 v10, v217, v8, v10
  v_dot2_f32_bf16 v9, v218, v8, v9
  v_dot2_f32_bf16 v10, v219, v8, v10
  v_dot2_f32_bf16 v9, v220, v8, v9
  v_dot2_f32_bf16 v10, v221, v8, v10
  v_dot2_f32_bf16 v9, v222, v8, v9
  v_dot2_f32_bf16 v10, v223, v8, v10
  s_nop 2
  v_add_f32 v9, v9, v10
  v_mov_b32 v10, v9
  s_nop 1
  v_permlane32_swap_b32 v9, v10
  v_add_f32 v9, v9, v10
  v_lshl_add_u32 v10, v3, 2, s71
  ds_write_b32 v10, v9
  v_lshl_add_u32 v10, v4, 4, s71
  s_lshl_b32 s6, s3, 2
  v_add_u32 v5, s6, v13
  s_waitcnt vmcnt(1)
  s_barrier
  ds_read_b128 v[240:243], v7 offset:0
  ds_read_b128 v[244:247], v7 offset:1024
  ds_read_b128 v[248:251], v7 offset:2048
  ds_read_b128 v[236:239], v7 offset:3072
  s_waitcnt lgkmcnt(3)
  v_mfma_f32_32x32x16_bf16 v[16:31], v[64:67], v[240:243], 0
  ds_read_b128 v[240:243], v7 offset:4096
  s_add_u32 s6, s91, 24576
  s_add_u32 m0, s92, 106496
  s_nop 0
  buffer_load_dwordx4 v2, s[8:11], s6 offen offset:0 sc1 lds
  s_waitcnt lgkmcnt(3)
  v_mfma_f32_32x32x16_bf16 v[16:31], v[68:71], v[244:247], v[16:31]
  ds_read_b128 v[244:247], v7 offset:5120
  s_add_u32 s6, s91, 32768
  s_add_u32 m0, s92, 114688
  s_nop 0
  buffer_load_dwordx4 v2, s[8:11], s6 offen offset:0 sc1 lds
  s_waitcnt lgkmcnt(3)
  v_mfma_f32_32x32x16_bf16 v[16:31], v[72:75], v[248:251], v[16:31]
  ds_read_b128 v[248:251], v7 offset:6144
  s_add_u32 s6, s91, 40960
  s_add_u32 m0, s92, 122880
  s_nop 0
  buffer_load_dwordx4 v2, s[8:11], s6 offen offset:0 sc1 lds
  s_waitcnt lgkmcnt(3)
  v_mfma_f32_32x32x16_bf16 v[16:31], v[76:79], v[236:239], v[16:31]
  ds_read_b128 v[236:239], v7 offset:7168
  s_add_u32 s6, s91, 49152
  s_add_u32 m0, s92, 131072
  s_nop 0
  buffer_load_dwordx4 v2, s[8:11], s6 offen offset:0 sc1 lds
  s_waitcnt lgkmcnt(3)
  v_mfma_f32_32x32x16_bf16 v[16:31], v[80:83], v[240:243], v[16:31]
  ds_read_b128 v[240:243], v7 offset:8192
  s_add_u32 s6, s91, 57344
  s_add_u32 m0, s92, 139264
  s_nop 0
  buffer_load_dwordx4 v2, s[8:11], s6 offen offset:0 sc1 lds
  s_waitcnt lgkmcnt(3)
  v_mfma_f32_32x32x16_bf16 v[16:31], v[84:87], v[244:247], v[16:31]
  ds_read_b128 v[244:247], v7 offset:9216
  s_add_u32 m0, s92, 0
  s_nop 0
  buffer_load_dwordx4 v2, s[8:11], s95 offen offset:0 sc1 lds
  s_waitcnt lgkmcnt(3)
  v_mfma_f32_32x32x16_bf16 v[16:31], v[88:91], v[248:251], v[16:31]
  ds_read_b128 v[248:251], v7 offset:10240
  s_add_u32 s6, s95, 8192
  s_add_u32 m0, s92, 8192
  s_nop 0
  buffer_load_dwordx4 v2, s[8:11], s6 offen offset:0 sc1 lds
  s_waitcnt lgkmcnt(3)
  v_mfma_f32_32x32x16_bf16 v[16:31], v[92:95], v[236:239], v[16:31]
  ds_read_b128 v[236:239], v7 offset:11264
  s_waitcnt lgkmcnt(3)
  v_mfma_f32_32x32x16_bf16 v[16:31], v[128:131], v[240:243], v[16:31]
  ds_read_b128 v[240:243], v7 offset:12288
  s_waitcnt lgkmcnt(3)
  v_mfma_f32_32x32x16_bf16 v[16:31], v[132:135], v[244:247], v[16:31]
  ds_read_b128 v[244:247], v7 offset:13312
  s_waitcnt lgkmcnt(3)
  v_mfma_f32_32x32x16_bf16 v[16:31], v[136:139], v[248:251], v[16:31]
  ds_read_b128 v[248:251], v7 offset:14336
  s_waitcnt lgkmcnt(3)
  v_mfma_f32_32x32x16_bf16 v[16:31], v[140:143], v[236:239], v[16:31]
  s_waitcnt vmcnt(6)
  s_barrier
  ds_read_b128 v[236:239], v7 offset:15360
  s_waitcnt lgkmcnt(3)
  v_mfma_f32_32x32x16_bf16 v[16:31], v[144:147], v[240:243], v[16:31]
  ds_read_b128 v[240:243], v7 offset:16384
  ds_read_b128 v[48:51], v10 offset:0
  ds_read_b128 v[52:55], v10 offset:32
  ds_read_b128 v[56:59], v10 offset:64
  ds_read_b128 v[60:63], v10 offset:96
  s_waitcnt lgkmcnt(7)
  v_mfma_f32_32x32x16_bf16 v[16:31], v[148:151], v[244:247], v[16:31]
  ds_read_b128 v[244:247], v7 offset:17408
  s_waitcnt lgkmcnt(7)
  v_mfma_f32_32x32x16_bf16 v[16:31], v[152:155], v[248:251], v[16:31]
  ds_read_b128 v[248:251], v7 offset:18432
  s_waitcnt lgkmcnt(7)
  v_mfma_f32_32x32x16_bf16 v[16:31], v[156:159], v[236:239], v[16:31]
  ds_read_b128 v[236:239], v7 offset:19456
  s_waitcnt lgkmcnt(7)
  v_mfma_f32_32x32x16_bf16 v[16:31], v[160:163], v[240:243], v[16:31]
  ds_read_b128 v[240:243], v7 offset:20480
  s_waitcnt lgkmcnt(3)
  v_mfma_f32_32x32x16_bf16 v[16:31], v[164:167], v[244:247], v[16:31]
  s_waitcnt vmcnt(0)
  v_add_u32 v11, s92, v11
  ds_read_b32 v32, v11 offset:0
  ds_read_b32 v33, v11 offset:256
  ds_read_b32 v34, v11 offset:512
  ds_read_b32 v35, v11 offset:768
  ds_read_b32 v36, v11 offset:8192
  ds_read_b32 v37, v11 offset:8448
  ds_read_b32 v38, v11 offset:8704
  ds_read_b32 v39, v11 offset:8960
  s_waitcnt lgkmcnt(6)
  v_add_f32 v32, v32, v33
  s_waitcnt lgkmcnt(4)
  v_add_f32 v34, v34, v35
  v_add_f32 v32, v32, v34
  ds_write_b32 v5, v32 offset:0
  s_waitcnt lgkmcnt(3)
  v_add_f32 v36, v36, v37
  s_waitcnt lgkmcnt(1)
  v_add_f32 v38, v38, v39
  v_add_f32 v36, v36, v38
  ds_write_b32 v5, v36 offset:2048
  s_waitcnt lgkmcnt(0)
  s_barrier
  ds_read_b128 v[244:247], v7 offset:21504
  v_mfma_f32_32x32x16_bf16 v[16:31], v[168:171], v[248:251], v[16:31]
  ds_read_b128 v[248:251], v7 offset:22528
  buffer_load_dwordx4 v[224:227], v2, s[8:11], s86 offen offset:0 sc1
  v_mfma_f32_32x32x16_bf16 v[16:31], v[172:175], v[236:239], v[16:31]
  ds_read_b128 v[236:239], v7 offset:23552
  v_mfma_f32_32x32x16_bf16 v[16:31], v[176:179], v[240:243], v[16:31]
  ds_read_b128 v[240:243], v7 offset:24576
  buffer_load_dwordx4 v[228:231], v2, s[8:11], s86 offen offset:1024 sc1
  s_waitcnt lgkmcnt(3)
  v_mfma_f32_32x32x16_bf16 v[16:31], v[180:183], v[244:247], v[16:31]
  ds_read_b128 v[244:247], v7 offset:25600
  s_waitcnt lgkmcnt(3)
  v_mfma_f32_32x32x16_bf16 v[16:31], v[184:187], v[248:251], v[16:31]
  ds_read_b128 v[248:251], v7 offset:26624
  buffer_load_dwordx4 v[232:235], v2, s[8:11], s86 offen offset:2048 sc1
  s_waitcnt lgkmcnt(3)
  v_mfma_f32_32x32x16_bf16 v[16:31], v[188:191], v[236:239], v[16:31]
  ds_read_b128 v[236:239], v7 offset:27648
  s_waitcnt lgkmcnt(3)
  v_mfma_f32_32x32x16_bf16 v[16:31], v[192:195], v[240:243], v[16:31]
  ds_read_b128 v[240:243], v7 offset:28672
  ds_read_b128 v[40:43], v13 offset:0
  ds_read_b128 v[44:47], v13 offset:16
  s_waitcnt lgkmcnt(1)
  v_add_f32 v40, v40, v41
  v_add_f32 v42, v42, v43
  s_waitcnt lgkmcnt(0)
  v_add_f32 v44, v44, v45
  v_add_f32 v46, v46, v47
  v_add_f32 v40, v40, v42
  v_add_f32 v44, v44, v46
  v_add_f32 v40, v40, v44
  v_mov_b32 v41, v40
  s_nop 1
  v_permlane32_swap_b32 v40, v41
  v_mul_f32 v9, 0x3b000000, v40
  v_mul_f32 v41, 0x3b000000, v41
  v_fma_f32 v41, -v9, v9, v41
  v_max_f32 v41, 0, v41
  v_add_f32 v41, 0x3727c5ac, v41
  v_rsq_f32 v10, v41
  v_sub_f32 v9, 0, v9
  v_rcp_f32 v254, v10
  v_mul_f32 v253, v10, v10
  v_mul_f32 v252, 0xc0135761, v10
  v_mul_f32 v253, v253, v10
  v_mul_f32 v253, 0xbdd2d3e8, v253
  buffer_load_dwordx4 v[96:99], v2, s[8:11], s86 offen offset:3072 sc1
  v_mfma_f32_32x32x16_bf16 v[16:31], v[196:199], v[244:247], v[16:31]
  ds_read_b128 v[244:247], v7 offset:29696
  v_mfma_f32_32x32x16_bf16 v[16:31], v[200:203], v[248:251], v[16:31]
  ds_read_b128 v[248:251], v7 offset:30720
  s_add_u32 s7, s86, 4096
  buffer_load_dwordx4 v[100:103], v2, s[8:11], s7 offen offset:0 sc1
  v_mfma_f32_32x32x16_bf16 v[16:31], v[204:207], v[236:239], v[16:31]
  ds_read_b128 v[236:239], v7 offset:31744
  v_mfma_f32_32x32x16_bf16 v[16:31], v[208:211], v[240:243], v[16:31]
  ds_read_b128 v[240:243], v7 offset:32768
  s_add_u32 s7, s86, 4096
  buffer_load_dwordx4 v[104:107], v2, s[8:11], s7 offen offset:1024 sc1
  s_waitcnt lgkmcnt(3)
  v_mfma_f32_32x32x16_bf16 v[16:31], v[212:215], v[244:247], v[16:31]
  ds_read_b128 v[244:247], v7 offset:33792
  s_waitcnt lgkmcnt(3)
  v_mfma_f32_32x32x16_bf16 v[16:31], v[216:219], v[248:251], v[16:31]
  ds_read_b128 v[248:251], v7 offset:34816
  s_add_u32 s7, s86, 4096
  buffer_load_dwordx4 v[108:111], v2, s[8:11], s7 offen offset:2048 sc1
  s_waitcnt lgkmcnt(3)
  v_mfma_f32_32x32x16_bf16 v[16:31], v[220:223], v[236:239], v[16:31]
  ds_read_b128 v[236:239], v7 offset:35840
  s_nop 10
  v_fmac_f32 v16, v9, v48
  v_fmac_f32 v17, v9, v49
  v_fmac_f32 v18, v9, v50
  v_fmac_f32 v19, v9, v51
  v_fmac_f32 v20, v9, v52
  v_fmac_f32 v21, v9, v53
  s_add_u32 s7, s86, 4096
  buffer_load_dwordx4 v[112:115], v2, s[8:11], s7 offen offset:3072 sc1
  v_fmac_f32 v22, v9, v54
  v_fmac_f32 v23, v9, v55
  v_mul_f32 v40, v16, v16
  v_mul_f32 v41, v17, v17
  v_mul_f32 v42, v18, v18
  v_mul_f32 v43, v19, v19
  v_mul_f32 v44, v20, v20
  v_mul_f32 v45, v21, v21
  v_mul_f32 v46, v22, v22
  v_mul_f32 v47, v23, v23
  v_fma_f32 v40, v40, v253, v252
  v_fma_f32 v41, v41, v253, v252
  v_fma_f32 v42, v42, v253, v252
  v_fma_f32 v43, v43, v253, v252
  v_fma_f32 v44, v44, v253, v252
  v_fma_f32 v45, v45, v253, v252
  v_fma_f32 v46, v46, v253, v252
  v_fma_f32 v47, v47, v253, v252
  v_mul_f32 v40, v40, v16
  v_mul_f32 v41, v41, v17
  v_mul_f32 v42, v42, v18
  v_mul_f32 v43, v43, v19
  v_mul_f32 v44, v44, v20
  v_mul_f32 v45, v45, v21
  s_add_u32 s7, s86, 8192
  buffer_load_dwordx4 v[116:119], v2, s[8:11], s7 offen offset:0 sc1
  v_mul_f32 v46, v46, v22
  v_mul_f32 v47, v47, v23
  v_exp_f32 v40, v40
  v_exp_f32 v41, v41
  v_exp_f32 v42, v42
  v_exp_f32 v43, v43
  v_exp_f32 v44, v44
  v_exp_f32 v45, v45
  v_exp_f32 v46, v46
  v_exp_f32 v47, v47
  v_fma_f32 v40, v40, v254, v254
  v_fma_f32 v41, v41, v254, v254
  v_fma_f32 v42, v42, v254, v254
  v_fma_f32 v43, v43, v254, v254
  v_fma_f32 v44, v44, v254, v254
  v_fma_f32 v45, v45, v254, v254
  v_fma_f32 v46, v46, v254, v254
  v_fma_f32 v47, v47, v254, v254
  v_rcp_f32 v40, v40
  v_rcp_f32 v41, v41
  v_rcp_f32 v42, v42
  v_rcp_f32 v43, v43
  v_rcp_f32 v44, v44
  v_rcp_f32 v45, v45
  s_add_u32 s7, s86, 8192
  buffer_load_dwordx4 v[120:123], v2, s[8:11], s7 offen offset:1024 sc1
  v_rcp_f32 v46, v46
  v_rcp_f32 v47, v47
  v_mul_f32 v16, v16, v40
  v_mul_f32 v17, v17, v41
  v_mul_f32 v18, v18, v42
  v_mul_f32 v19, v19, v43
  v_mul_f32 v20, v20, v44
  v_mul_f32 v21, v21, v45
  v_mul_f32 v22, v22, v46
  v_mul_f32 v23, v23, v47
  v_cvt_pk_bf16_f32 v16, v16, v17
  v_cvt_pk_bf16_f32 v17, v18, v19
  v_cvt_pk_bf16_f32 v18, v20, v21
  v_cvt_pk_bf16_f32 v19, v22, v23
  buffer_store_dwordx4 v[16:19], v2, s[8:11], s93 offen offset:0 sc1
  v_fmac_f32 v24, v9, v56
  v_fmac_f32 v25, v9, v57
  v_fmac_f32 v26, v9, v58
  v_fmac_f32 v27, v9, v59
  v_fmac_f32 v28, v9, v60
  v_fmac_f32 v29, v9, v61
  v_fmac_f32 v30, v9, v62
  v_fmac_f32 v31, v9, v63
  v_mul_f32 v40, v24, v24
  s_add_u32 s7, s86, 8192
  buffer_load_dwordx4 v[124:127], v2, s[8:11], s7 offen offset:2048 sc1
  v_mul_f32 v41, v25, v25
  v_mul_f32 v42, v26, v26
  v_mul_f32 v43, v27, v27
  v_mul_f32 v44, v28, v28
  v_mul_f32 v45, v29, v29
  v_mul_f32 v46, v30, v30
  v_mul_f32 v47, v31, v31
  v_fma_f32 v40, v40, v253, v252
  v_fma_f32 v41, v41, v253, v252
  v_fma_f32 v42, v42, v253, v252
  v_fma_f32 v43, v43, v253, v252
  v_fma_f32 v44, v44, v253, v252
  v_fma_f32 v45, v45, v253, v252
  v_fma_f32 v46, v46, v253, v252
  v_fma_f32 v47, v47, v253, v252
  v_mul_f32 v40, v40, v24
  v_mul_f32 v41, v41, v25
  v_mul_f32 v42, v42, v26
  v_mul_f32 v43, v43, v27
  v_mul_f32 v44, v44, v28
  v_mul_f32 v45, v45, v29
  v_mul_f32 v46, v46, v30
  v_mul_f32 v47, v47, v31
  v_exp_f32 v40, v40
  v_exp_f32 v41, v41
  v_exp_f32 v42, v42
  v_exp_f32 v43, v43
  v_exp_f32 v44, v44
  v_exp_f32 v45, v45
  v_exp_f32 v46, v46
  v_exp_f32 v47, v47
  v_fma_f32 v40, v40, v254, v254
  v_fma_f32 v41, v41, v254, v254
  v_fma_f32 v42, v42, v254, v254
  v_fma_f32 v43, v43, v254, v254
  v_fma_f32 v44, v44, v254, v254
  v_fma_f32 v45, v45, v254, v254
  v_fma_f32 v46, v46, v254, v254
  v_fma_f32 v47, v47, v254, v254
  v_rcp_f32 v40, v40
  v_rcp_f32 v41, v41
  v_rcp_f32 v42, v42
  v_rcp_f32 v43, v43
  v_rcp_f32 v44, v44
  v_rcp_f32 v45, v45
  v_rcp_f32 v46, v46
  v_rcp_f32 v47, v47
  v_mul_f32 v24, v24, v40
  v_mul_f32 v25, v25, v41
  v_mul_f32 v26, v26, v42
  v_mul_f32 v27, v27, v43
  v_mul_f32 v28, v28, v44
  v_mul_f32 v29, v29, v45
  v_mul_f32 v30, v30, v46
  v_mul_f32 v31, v31, v47
  v_cvt_pk_bf16_f32 v24, v24, v25
  v_cvt_pk_bf16_f32 v25, v26, v27
  v_cvt_pk_bf16_f32 v26, v28, v29
  v_cvt_pk_bf16_f32 v27, v30, v31
  buffer_store_dwordx4 v[24:27], v2, s[8:11], s93 offen offset:1024 sc1
  ds_read_b128 v[40:43], v13 offset:2048
  ds_read_b128 v[44:47], v13 offset:2064
  s_waitcnt lgkmcnt(1)
  v_add_f32 v40, v40, v41
  v_add_f32 v42, v42, v43
  s_waitcnt lgkmcnt(0)
  v_add_f32 v44, v44, v45
  v_add_f32 v46, v46, v47
  v_add_f32 v40, v40, v42
  v_add_f32 v44, v44, v46
  v_add_f32 v40, v40, v44
  v_mov_b32 v41, v40
  s_nop 1
  v_permlane32_swap_b32 v40, v41
  v_mul_f32 v9, 0x3b000000, v40
  v_mul_f32 v41, 0x3b000000, v41
  v_fma_f32 v41, -v9, v9, v41
  v_max_f32 v41, 0, v41
  v_add_f32 v41, 0x3727c5ac, v41
  v_rsq_f32 v10, v41
  v_sub_f32 v9, 0, v9
  v_rcp_f32 v254, v10
  v_mul_f32 v253, v10, v10
  v_mul_f32 v252, 0xc0135761, v10
  v_mul_f32 v253, v253, v10
  v_mul_f32 v253, 0xbdd2d3e8, v253
  v_mfma_f32_32x32x16_bf16 v[32:47], v[64:67], v[240:243], 0
  ds_read_b128 v[240:243], v7 offset:36864
  v_mfma_f32_32x32x16_bf16 v[32:47], v[68:71], v[244:247], v[32:47]
  ds_read_b128 v[244:247], v7 offset:37888
  v_mfma_f32_32x32x16_bf16 v[32:47], v[72:75], v[248:251], v[32:47]
  ds_read_b128 v[248:251], v7 offset:38912
  s_add_u32 s7, s86, 8192
  buffer_load_dwordx4 v[72:75], v2, s[8:11], s7 offen offset:3072 sc1
  v_mfma_f32_32x32x16_bf16 v[32:47], v[76:79], v[236:239], v[32:47]
  ds_read_b128 v[236:239], v7 offset:39936
  s_waitcnt lgkmcnt(3)
  v_mfma_f32_32x32x16_bf16 v[32:47], v[80:83], v[240:243], v[32:47]
  ds_read_b128 v[240:243], v7 offset:40960
  s_add_u32 s7, s86, 12288
  buffer_load_dwordx4 v[76:79], v2, s[8:11], s7 offen offset:0 sc1
  s_waitcnt lgkmcnt(3)
  v_mfma_f32_32x32x16_bf16 v[32:47], v[84:87], v[244:247], v[32:47]
  ds_read_b128 v[244:247], v7 offset:41984
  s_waitcnt lgkmcnt(3)
  v_mfma_f32_32x32x16_bf16 v[32:47], v[88:91], v[248:251], v[32:47]
  ds_read_b128 v[248:251], v7 offset:43008
  s_add_u32 s7, s86, 12288
  buffer_load_dwordx4 v[80:83], v2, s[8:11], s7 offen offset:1024 sc1
  s_waitcnt lgkmcnt(3)
  v_mfma_f32_32x32x16_bf16 v[32:47], v[92:95], v[236:239], v[32:47]
  ds_read_b128 v[236:239], v7 offset:44032
  s_waitcnt lgkmcnt(3)
  v_mfma_f32_32x32x16_bf16 v[32:47], v[128:131], v[240:243], v[32:47]
  ds_read_b128 v[240:243], v7 offset:45056
  s_waitcnt vmcnt(3)
  s_mov_b64 exec, 1
  v_mov_b32 v5, 1
  v_mov_b32 v6, 161792
  ds_add_rtn_u32 v5, v6, v5
  s_waitcnt lgkmcnt(0)
  v_readfirstlane_b32 s5, v5
  s_mov_b64 exec, -1
  s_lshl_b32 s4, s61, 4
  s_add_u32 s4, s4, 2379776
  s_cmp_lg_u32 s5, 7
  s_cselect_b32 s4, 2146435072, s4
  v_mov_b32 v5, s56
  s_cmp_lg_u32 s87, 0
  s_cbranch_scc1 L_dp7
  buffer_store_dword v5, v14, s[8:11], s4 offen sc1
  s_branch L_dj7
L_dp7:
  buffer_store_dword v5, v14, s[8:11], s4 offen
L_dj7:
  s_add_u32 s7, s86, 12288
  buffer_load_dwordx4 v[84:87], v2, s[8:11], s7 offen offset:2048 sc1
  v_mfma_f32_32x32x16_bf16 v[32:47], v[132:135], v[244:247], v[32:47]
  ds_read_b128 v[244:247], v7 offset:46080
  v_mfma_f32_32x32x16_bf16 v[32:47], v[136:139], v[248:251], v[32:47]
  ds_read_b128 v[248:251], v7 offset:47104
  s_add_u32 s7, s86, 12288
  buffer_load_dwordx4 v[88:91], v2, s[8:11], s7 offen offset:3072 sc1
  v_mfma_f32_32x32x16_bf16 v[32:47], v[140:143], v[236:239], v[32:47]
  ds_read_b128 v[236:239], v7 offset:48128
  v_mfma_f32_32x32x16_bf16 v[32:47], v[144:147], v[240:243], v[32:47]
  ds_read_b128 v[240:243], v7 offset:49152
  s_add_u32 s7, s86, 16384
  buffer_load_dwordx4 v[92:95], v2, s[8:11], s7 offen offset:0 sc1
  s_waitcnt lgkmcnt(3)
  v_mfma_f32_32x32x16_bf16 v[32:47], v[148:151], v[244:247], v[32:47]
  ds_read_b128 v[244:247], v7 offset:50176
  s_waitcnt lgkmcnt(3)
  v_mfma_f32_32x32x16_bf16 v[32:47], v[152:155], v[248:251], v[32:47]
  ds_read_b128 v[248:251], v7 offset:51200
  s_add_u32 s7, s86, 16384
  buffer_load_dwordx4 v[128:131], v2, s[8:11], s7 offen offset:1024 sc1
  s_waitcnt lgkmcnt(3)
  v_mfma_f32_32x32x16_bf16 v[32:47], v[156:159], v[236:239], v[32:47]
  ds_read_b128 v[236:239], v7 offset:52224
  s_waitcnt lgkmcnt(3)
  v_mfma_f32_32x32x16_bf16 v[32:47], v[160:163], v[240:243], v[32:47]
  ds_read_b128 v[240:243], v7 offset:53248
  s_add_u32 s7, s86, 16384
  buffer_load_dwordx4 v[132:135], v2, s[8:11], s7 offen offset:2048 sc1
  s_waitcnt lgkmcnt(3)
  v_mfma_f32_32x32x16_bf16 v[32:47], v[164:167], v[244:247], v[32:47]
  ds_read_b128 v[244:247], v7 offset:54272
  s_waitcnt lgkmcnt(3)
  v_mfma_f32_32x32x16_bf16 v[32:47], v[168:171], v[248:251], v[32:47]
  ds_read_b128 v[248:251], v7 offset:55296
  s_add_u32 s7, s86, 16384
  buffer_load_dwordx4 v[136:139], v2, s[8:11], s7 offen offset:3072 sc1
  s_waitcnt lgkmcnt(3)
  v_mfma_f32_32x32x16_bf16 v[32:47], v[172:175], v[236:239], v[32:47]
  ds_read_b128 v[236:239], v7 offset:56320
  s_waitcnt lgkmcnt(3)
  v_mfma_f32_32x32x16_bf16 v[32:47], v[176:179], v[240:243], v[32:47]
  ds_read_b128 v[240:243], v7 offset:57344
  s_add_u32 s7, s86, 20480
  buffer_load_dwordx4 v[140:143], v2, s[8:11], s7 offen offset:0 sc1
  s_waitcnt lgkmcnt(3)
  v_mfma_f32_32x32x16_bf16 v[32:47], v[180:183], v[244:247], v[32:47]
  ds_read_b128 v[244:247], v7 offset:58368
  s_waitcnt lgkmcnt(3)
  v_mfma_f32_32x32x16_bf16 v[32:47], v[184:187], v[248:251], v[32:47]
  ds_read_b128 v[248:251], v7 offset:59392
  s_add_u32 s7, s86, 20480
  buffer_load_dwordx4 v[144:147], v2, s[8:11], s7 offen offset:1024 sc1
  s_waitcnt lgkmcnt(3)
  v_mfma_f32_32x32x16_bf16 v[32:47], v[188:191], v[236:239], v[32:47]
  ds_read_b128 v[236:239], v7 offset:60416
  s_waitcnt lgkmcnt(3)
  v_mfma_f32_32x32x16_bf16 v[32:47], v[192:195], v[240:243], v[32:47]
  ds_read_b128 v[240:243], v7 offset:61440
  s_add_u32 s7, s86, 20480
  buffer_load_dwordx4 v[148:151], v2, s[8:11], s7 offen offset:2048 sc1
  s_waitcnt lgkmcnt(3)
  v_mfma_f32_32x32x16_bf16 v[32:47], v[196:199], v[244:247], v[32:47]
  ds_read_b128 v[244:247], v7 offset:62464
  s_waitcnt lgkmcnt(3)
  v_mfma_f32_32x32x16_bf16 v[32:47], v[200:203], v[248:251], v[32:47]
  ds_read_b128 v[248:251], v7 offset:63488
  s_add_u32 s7, s86, 20480
  buffer_load_dwordx4 v[152:155], v2, s[8:11], s7 offen offset:3072 sc1
  s_waitcnt lgkmcnt(3)
  v_mfma_f32_32x32x16_bf16 v[32:47], v[204:207], v[236:239], v[32:47]
  ds_read_b128 v[236:239], v7 offset:64512
  s_waitcnt lgkmcnt(3)
  v_mfma_f32_32x32x16_bf16 v[32:47], v[208:211], v[240:243], v[32:47]
  s_add_u32 s7, s86, 24576
  buffer_load_dwordx4 v[156:159], v2, s[8:11], s7 offen offset:0 sc1
  s_waitcnt lgkmcnt(2)
  v_mfma_f32_32x32x16_bf16 v[32:47], v[212:215], v[244:247], v[32:47]
  s_waitcnt lgkmcnt(1)
  v_mfma_f32_32x32x16_bf16 v[32:47], v[216:219], v[248:251], v[32:47]
  s_add_u32 s7, s86, 24576
  buffer_load_dwordx4 v[160:163], v2, s[8:11], s7 offen offset:1024 sc1
  s_waitcnt lgkmcnt(0)
  v_mfma_f32_32x32x16_bf16 v[32:47], v[220:223], v[236:239], v[32:47]
  s_mov_b32 s95, s94
  s_load_dwordx2 s[52:53], s[0:1], 104
  s_mov_b32 s54, 2097152
  s_mul_i32 s6, s59, 512
  s_mul_i32 s92, s3, 14
  s_add_u32 s6, s6, s92
  s_lshl_b32 s6, s6, 10
  s_add_u32 s91, s6, 10682368
  s_lshl_b32 s92, s92, 10
  s_lshl_b32 s6, s59, 16
  s_add_u32 s6, s6, s92
  s_add_u32 s78, s6, 10551296
  s_add_u32 s78, s78, s96
  s_add_u32 s7, s6, 4294901760
  s_cmp_ge_u32 s3, 4
  s_cselect_b32 s79, s7, s78
  s_cmp_ge_u32 s3, 5
  s_cselect_b32 s78, s7, s78
  v_and_b32 v5, 7, v1
  v_min_u32 v5, 6, v5
  s_lshl_b32 s6, s59, 3
  v_add_u32 v5, s6, v5
  v_lshlrev_b32 v13, 4, v5
  v_fmac_f32 v32, v9, v48
  v_fmac_f32 v33, v9, v49
  v_fmac_f32 v34, v9, v50
  v_fmac_f32 v35, v9, v51
  s_add_u32 s7, s86, 24576
  buffer_load_dwordx4 v[164:167], v2, s[8:11], s7 offen offset:2048 sc1
  v_fmac_f32 v36, v9, v52
  v_fmac_f32 v37, v9, v53
  v_fmac_f32 v38, v9, v54
  v_fmac_f32 v39, v9, v55
  v_mul_f32 v172, v32, v32
  v_mul_f32 v173, v33, v33
  v_mul_f32 v174, v34, v34
  v_mul_f32 v175, v35, v35
  v_mul_f32 v176, v36, v36
  v_mul_f32 v177, v37, v37
  v_mul_f32 v178, v38, v38
  v_mul_f32 v179, v39, v39
  s_add_u32 s7, s86, 24576
  buffer_load_dwordx4 v[168:171], v2, s[8:11], s7 offen offset:3072 sc1
  v_fma_f32 v172, v172, v253, v252
  v_fma_f32 v173, v173, v253, v252
  v_fma_f32 v174, v174, v253, v252
  v_fma_f32 v175, v175, v253, v252
  v_fma_f32 v176, v176, v253, v252
  v_fma_f32 v177, v177, v253, v252
  v_fma_f32 v178, v178, v253, v252
  v_fma_f32 v179, v179, v253, v252
  v_mul_f32 v172, v172, v32
  v_mul_f32 v173, v173, v33
  v_mul_f32 v174, v174, v34
  v_mul_f32 v175, v175, v35
  v_mul_f32 v176, v176, v36
  v_mul_f32 v177, v177, v37
  v_mul_f32 v178, v178, v38
  v_mul_f32 v179, v179, v39
  v_exp_f32 v172, v172
  v_exp_f32 v173, v173
  v_exp_f32 v174, v174
  v_exp_f32 v175, v175
  v_exp_f32 v176, v176
  v_exp_f32 v177, v177
  v_exp_f32 v178, v178
  v_exp_f32 v179, v179
  v_fma_f32 v172, v172, v254, v254
  v_fma_f32 v173, v173, v254, v254
  v_fma_f32 v174, v174, v254, v254
  v_fma_f32 v175, v175, v254, v254
  v_fma_f32 v176, v176, v254, v254
  v_fma_f32 v177, v177, v254, v254
  v_fma_f32 v178, v178, v254, v254
  v_fma_f32 v179, v179, v254, v254
  v_rcp_f32 v172, v172
  v_rcp_f32 v173, v173
  v_rcp_f32 v174, v174
  v_rcp_f32 v175, v175
  v_rcp_f32 v176, v176
  v_rcp_f32 v177, v177
  v_rcp_f32 v178, v178
  v_rcp_f32 v179, v179
  v_mul_f32 v32, v32, v172
  v_mul_f32 v33, v33, v173
  v_mul_f32 v34, v34, v174
  v_mul_f32 v35, v35, v175
  v_mul_f32 v36, v36, v176
  v_mul_f32 v37, v37, v177
  v_mul_f32 v38, v38, v178
  v_mul_f32 v39, v39, v179
  v_cvt_pk_bf16_f32 v32, v32, v33
  v_cvt_pk_bf16_f32 v33, v34, v35
  v_cvt_pk_bf16_f32 v34, v36, v37
  v_cvt_pk_bf16_f32 v35, v38, v39
  buffer_store_dwordx4 v[32:35], v2, s[8:11], s95 offen offset:0 sc1
  v_fmac_f32 v40, v9, v56
  v_fmac_f32 v41, v9, v57
  v_fmac_f32 v42, v9, v58
  v_fmac_f32 v43, v9, v59
  v_fmac_f32 v44, v9, v60
  v_fmac_f32 v45, v9, v61
  v_fmac_f32 v46, v9, v62
  v_fmac_f32 v47, v9, v63
  v_mul_f32 v172, v40, v40
  v_mul_f32 v173, v41, v41
  v_mul_f32 v174, v42, v42
  v_mul_f32 v175, v43, v43
  v_mul_f32 v176, v44, v44
  v_mul_f32 v177, v45, v45
  v_mul_f32 v178, v46, v46
  v_mul_f32 v179, v47, v47
  v_fma_f32 v172, v172, v253, v252
  v_fma_f32 v173, v173, v253, v252
  v_fma_f32 v174, v174, v253, v252
  v_fma_f32 v175, v175, v253, v252
  v_fma_f32 v176, v176, v253, v252
  v_fma_f32 v177, v177, v253, v252
  v_fma_f32 v178, v178, v253, v252
  v_fma_f32 v179, v179, v253, v252
  v_mul_f32 v172, v172, v40
  v_mul_f32 v173, v173, v41
  v_mul_f32 v174, v174, v42
  v_mul_f32 v175, v175, v43
  v_mul_f32 v176, v176, v44
  v_mul_f32 v177, v177, v45
  v_mul_f32 v178, v178, v46
  v_mul_f32 v179, v179, v47
  v_exp_f32 v172, v172
  v_exp_f32 v173, v173
  v_exp_f32 v174, v174
  v_exp_f32 v175, v175
  v_exp_f32 v176, v176
  v_exp_f32 v177, v177
  v_exp_f32 v178, v178
  v_exp_f32 v179, v179
  v_fma_f32 v172, v172, v254, v254
  v_fma_f32 v173, v173, v254, v254
  v_fma_f32 v174, v174, v254, v254
  v_fma_f32 v175, v175, v254, v254
  v_fma_f32 v176, v176, v254, v254
  v_fma_f32 v177, v177, v254, v254
  v_fma_f32 v178, v178, v254, v254
  v_fma_f32 v179, v179, v254, v254
  v_rcp_f32 v172, v172
  v_rcp_f32 v173, v173
  v_rcp_f32 v174, v174
  v_rcp_f32 v175, v175
  v_rcp_f32 v176, v176
  v_rcp_f32 v177, v177
  v_rcp_f32 v178, v178
  v_rcp_f32 v179, v179
  v_mul_f32 v40, v40, v172
  v_mul_f32 v41, v41, v173
  v_mul_f32 v42, v42, v174
  v_mul_f32 v43, v43, v175
  v_mul_f32 v44, v44, v176
  v_mul_f32 v45, v45, v177
  v_mul_f32 v46, v46, v178
  v_mul_f32 v47, v47, v179
  v_cvt_pk_bf16_f32 v40, v40, v41
  v_cvt_pk_bf16_f32 v41, v42, v43
  v_cvt_pk_bf16_f32 v42, v44, v45
  v_cvt_pk_bf16_f32 v43, v46, v47
  buffer_store_dwordx4 v[40:43], v2, s[8:11], s95 offen offset:1024 sc1
  s_setprio 0
  s_add_u32 s7, s90, 10485760
  s_add_u32 s7, s7, s96
  buffer_load_dwordx4 v[64:67], v2, s[8:11], s7 offen sc1
  s_mul_i32 s6, s84, 28672
  v_add_u32 v7, s6, v2
  s_lshl_b32 s6, s3, 12
  s_add_u32 s6, s6, 114688
  v_add_u32 v9, s6, v2
  v_add_u32 v12, s92, v2
  s_and_b32 s7, s84, 1
  s_lshl_b32 s7, s7, 11
  s_cmp_ge_u32 s84, 2
  s_movk_i32 s95, 4096
  s_cselect_b32 s95, 14336, s95
  s_cselect_b32 s6, 0, 114688
  s_add_u32 s6, s6, s7
  s_mul_i32 s7, s83, s95
  s_add_u32 s6, s6, s7
  v_add_u32 v10, s6, v2
  s_lshl_b32 s95, s95, 1
  v_lshlrev_b32 v11, 10, v3
  v_lshl_add_u32 v11, v4, 4, v11
  s_lshl_b32 s6, s88, 15
  s_lshl_b32 s7, s89, 5
  s_add_u32 s93, s6, s7
  s_lshl_b32 s6, s3, 6
  s_add_u32 s6, s6, 162048
  v_lshl_add_u32 v5, v4, 4, s6
  ds_read_b128 v[204:207], v5
  ds_read_b128 v[208:211], v5 offset:32
  v_lshlrev_b32 v5, 4, v0
  v_add_u32 v5, 147456, v5
  ds_read_b128 v[68:71], v5
  s_waitcnt lgkmcnt(0)
  v_lshlrev_b32 v220, 16, v68
  v_and_b32 v221, 0xffff0000, v68
  v_lshlrev_b32 v222, 16, v69
  v_and_b32 v223, 0xffff0000, v69
  v_lshlrev_b32 v236, 16, v70
  v_and_b32 v237, 0xffff0000, v70
  v_lshlrev_b32 v238, 16, v71
  v_and_b32 v239, 0xffff0000, v71
  v_mov_b32 v6, 161796
  s_cmp_lg_u32 s3, 0
  s_cbranch_scc1 L_d_lw
  s_mov_b32 s5, 2379776
  s_mov_b32 s6, 0
L_poll6:
  buffer_load_dword v252, v13, s[8:11], s5 offen sc1
  s_add_u32 s6, s6, 1
  s_waitcnt vmcnt(0)
  v_cmp_ne_u32 vcc, s56, v252
  s_cbranch_vccz L_polld6
  s_sleep 1
  s_cmp_lt_u32 s6, 0x40000
  s_cbranch_scc1 L_poll6
L_polld6:
  ds_write_b32 v6, v8
  s_branch L_d_join
L_d_lw:
  s_mov_b32 s6, 0
L_d_lw1:
  ds_read_b32 v252, v6
  s_add_u32 s6, s6, 1
  s_waitcnt lgkmcnt(0)
  v_cmp_eq_u32 vcc, 0, v252
  s_cbranch_vccz L_d_join
  s_sleep 1
  s_cmp_lt_u32 s6, 0x400000
  s_cbranch_scc1 L_d_lw1
  s_branch L_d_join
L_d_skip:
  buffer_load_dwordx4 v[224:227], v2, s[8:11], s86 offen offset:0 sc1
  buffer_load_dwordx4 v[228:231], v2, s[8:11], s86 offen offset:1024 sc1
  buffer_load_dwordx4 v[232:235], v2, s[8:11], s86 offen offset:2048 sc1
  buffer_load_dwordx4 v[96:99], v2, s[8:11], s86 offen offset:3072 sc1
  s_add_u32 s7, s86, 4096
  buffer_load_dwordx4 v[100:103], v2, s[8:11], s7 offen offset:0 sc1
  buffer_load_dwordx4 v[104:107], v2, s[8:11], s7 offen offset:1024 sc1
  buffer_load_dwordx4 v[108:111], v2, s[8:11], s7 offen offset:2048 sc1
  buffer_load_dwordx4 v[112:115], v2, s[8:11], s7 offen offset:3072 sc1
  s_add_u32 s7, s86, 8192
  buffer_load_dwordx4 v[116:119], v2, s[8:11], s7 offen offset:0 sc1
  buffer_load_dwordx4 v[120:123], v2, s[8:11], s7 offen offset:1024 sc1
  buffer_load_dwordx4 v[124:127], v2, s[8:11], s7 offen offset:2048 sc1
  buffer_load_dwordx4 v[72:75], v2, s[8:11], s7 offen offset:3072 sc1
  s_add_u32 s7, s86, 12288
  buffer_load_dwordx4 v[76:79], v2, s[8:11], s7 offen offset:0 sc1
  buffer_load_dwordx4 v[80:83], v2, s[8:11], s7 offen offset:1024 sc1
  buffer_load_dwordx4 v[84:87], v2, s[8:11], s7 offen offset:2048 sc1
  buffer_load_dwordx4 v[88:91], v2, s[8:11], s7 offen offset:3072 sc1
  s_add_u32 s7, s86, 16384
  s_waitcnt vmcnt(20)
  buffer_load_dwordx4 v[92:95], v2, s[8:11], s7 offen offset:0 sc1
  buffer_load_dwordx4 v[128:131], v2, s[8:11], s7 offen offset:1024 sc1
  buffer_load_dwordx4 v[132:135], v2, s[8:11], s7 offen offset:2048 sc1
  buffer_load_dwordx4 v[136:139], v2, s[8:11], s7 offen offset:3072 sc1
  s_add_u32 s7, s86, 20480
  buffer_load_dwordx4 v[140:143], v2, s[8:11], s7 offen offset:0 sc1
  buffer_load_dwordx4 v[144:147], v2, s[8:11], s7 offen offset:1024 sc1
  buffer_load_dwordx4 v[148:151], v2, s[8:11], s7 offen offset:2048 sc1
  buffer_load_dwordx4 v[152:155], v2, s[8:11], s7 offen offset:3072 sc1
  s_add_u32 s7, s86, 24576
  buffer_load_dwordx4 v[156:159], v2, s[8:11], s7 offen offset:0 sc1
  buffer_load_dwordx4 v[160:163], v2, s[8:11], s7 offen offset:1024 sc1
  buffer_load_dwordx4 v[164:167], v2, s[8:11], s7 offen offset:2048 sc1
  buffer_load_dwordx4 v[168:171], v2, s[8:11], s7 offen offset:3072 sc1
  s_load_dwordx2 s[52:53], s[0:1], 104
  s_mov_b32 s54, 2097152
  s_mul_i32 s6, s59, 512
  s_mul_i32 s92, s3, 14
  s_add_u32 s6, s6, s92
  s_lshl_b32 s6, s6, 10
  s_add_u32 s91, s6, 10682368
  s_lshl_b32 s92, s92, 10
  s_lshl_b32 s6, s59, 16
  s_add_u32 s6, s6, s92
  s_add_u32 s78, s6, 10551296
  s_add_u32 s78, s78, s96
  s_add_u32 s7, s6, 4294901760
  s_cmp_ge_u32 s3, 4
  s_cselect_b32 s79, s7, s78
  s_cmp_ge_u32 s3, 5
  s_cselect_b32 s78, s7, s78
  v_and_b32 v5, 7, v1
  v_min_u32 v5, 6, v5
  s_lshl_b32 s6, s59, 3
  v_add_u32 v5, s6, v5
  v_lshlrev_b32 v13, 4, v5
  s_add_u32 s7, s90, 10485760
  s_add_u32 s7, s7, s96
  buffer_load_dwordx4 v[64:67], v2, s[8:11], s7 offen sc1
  s_mul_i32 s6, s84, 28672
  v_add_u32 v7, s6, v2
  s_lshl_b32 s6, s3, 12
  s_add_u32 s6, s6, 114688
  v_add_u32 v9, s6, v2
  v_add_u32 v12, s92, v2
  s_and_b32 s7, s84, 1
  s_lshl_b32 s7, s7, 11
  s_cmp_ge_u32 s84, 2
  s_movk_i32 s95, 4096
  s_cselect_b32 s95, 14336, s95
  s_cselect_b32 s6, 0, 114688
  s_add_u32 s6, s6, s7
  s_mul_i32 s7, s83, s95
  s_add_u32 s6, s6, s7
  v_add_u32 v10, s6, v2
  s_lshl_b32 s95, s95, 1
  v_lshlrev_b32 v11, 10, v3
  v_lshl_add_u32 v11, v4, 4, v11
  s_lshl_b32 s6, s88, 15
  s_lshl_b32 s7, s89, 5
  s_add_u32 s93, s6, s7
  s_lshl_b32 s6, s3, 6
  s_add_u32 s6, s6, 162048
  v_lshl_add_u32 v5, v4, 4, s6
  ds_read_b128 v[204:207], v5
  ds_read_b128 v[208:211], v5 offset:32
  v_lshlrev_b32 v5, 4, v0
  v_add_u32 v5, 147456, v5
  ds_read_b128 v[68:71], v5
  s_waitcnt lgkmcnt(0)
  v_lshlrev_b32 v220, 16, v68
  v_and_b32 v221, 0xffff0000, v68
  v_lshlrev_b32 v222, 16, v69
  v_and_b32 v223, 0xffff0000, v69
  v_lshlrev_b32 v236, 16, v70
  v_and_b32 v237, 0xffff0000, v70
  v_lshlrev_b32 v238, 16, v71
  v_and_b32 v239, 0xffff0000, v71
  s_waitcnt vmcnt(0) lgkmcnt(0)
  s_mov_b32 s5, 2379776
  s_mov_b32 s6, 0
  s_cmp_lg_u32 s3, 0
  s_cbranch_scc1 L_polld7
L_poll7:
  buffer_load_dword v6, v13, s[8:11], s5 offen sc1
  s_add_u32 s6, s6, 1
  s_waitcnt vmcnt(0)
  v_cmp_ne_u32 vcc, s56, v6
  s_cbranch_vccz L_polld7
  s_sleep 8
  s_cmp_lt_u32 s6, 0x40000
  s_cbranch_scc1 L_poll7
L_polld7:
  s_barrier
L_d_join:
  s_nop 3
  s_waitcnt lgkmcnt(0)
  s_add_u32 m0, s92, 0
  s_nop 0
  buffer_load_dwordx4 v2, s[8:11], s91 offen offset:0 sc1 lds
  buffer_load_dwordx4 v2, s[8:11], s91 offen offset:1024 sc1 lds
  buffer_load_dwordx4 v2, s[8:11], s91 offen offset:2048 sc1 lds
  buffer_load_dwordx4 v2, s[8:11], s91 offen offset:3072 sc1 lds
  s_waitcnt vmcnt(4)
  s_mov_b64 exec, 1
  v_mov_b32 v5, 1
  v_mov_b32 v6, 161800
  ds_add_rtn_u32 v5, v6, v5
  s_waitcnt lgkmcnt(0)
  v_readfirstlane_b32 s5, v5
  s_mov_b64 exec, -1
  s_lshl_b32 s4, s61, 4
  s_add_u32 s4, s4, 2383872
  s_cmp_lg_u32 s5, 7
  s_cselect_b32 s4, 2146435072, s4
  v_mov_b32 v5, s56
  s_cmp_lg_u32 s87, 0
  s_cbranch_scc1 L_dp10
  buffer_store_dword v5, v14, s[8:11], s4 offen sc1
  s_branch L_dj10
L_dp10:
  buffer_store_dword v5, v14, s[8:11], s4 offen
L_dj10:
  s_add_u32 s6, s91, 4096
  s_add_u32 m0, s92, 4096
  s_nop 0
  buffer_load_dwordx4 v2, s[8:11], s6 offen offset:0 sc1 lds
  buffer_load_dwordx4 v2, s[8:11], s6 offen offset:1024 sc1 lds
  buffer_load_dwordx4 v2, s[8:11], s6 offen offset:2048 sc1 lds
  buffer_load_dwordx4 v2, s[8:11], s6 offen offset:3072 sc1 lds
  s_waitcnt vmcnt(5)
  s_barrier
  ds_read_b128 v[48:51], v7 offset:0
  ds_read_b128 v[52:55], v7 offset:14336
  ds_read_b128 v[56:59], v7 offset:1024
  ds_read_b128 v[60:63], v7 offset:15360
  ds_read_b128 v[240:243], v7 offset:2048
  ds_read_b128 v[244:247], v7 offset:16384
  ds_read_b128 v[248:251], v7 offset:3072
  ds_read_b128 v[252:255], v7 offset:17408
  s_add_u32 s6, s91, 8192
  s_add_u32 m0, s92, 8192
  s_nop 0
  buffer_load_dwordx4 v2, s[8:11], s6 offen offset:0 sc1 lds
  buffer_load_dwordx4 v2, s[8:11], s6 offen offset:1024 sc1 lds
  buffer_load_dwordx4 v2, s[8:11], s6 offen offset:2048 sc1 lds
  s_waitcnt vmcnt(3)
  s_barrier
  s_mov_b32 s5, 2383872
  v_mov_b32 v6, s56
  s_cmp_lg_u32 s3, 0
  s_cbranch_scc1 L_e_np
  buffer_load_dword v6, v13, s[8:11], s5 offen sc1
L_e_np:
  s_waitcnt lgkmcnt(7)
  v_mfma_f32_32x32x16_bf16 v[16:31], v[224:227], v[48:51], 0
  ds_read_b128 v[48:51], v7 offset:4096
  s_add_u32 s94, s91, 11264
  s_add_u32 m0, s92, 11264
  s_nop 0
  buffer_load_dwordx4 v2, s[8:11], s94 offen offset:0 sc1 lds
  s_waitcnt lgkmcnt(7)
  v_mfma_f32_32x32x16_bf16 v[16:31], v[84:87], v[52:55], v[16:31]
  ds_read_b128 v[52:55], v7 offset:18432
  s_waitcnt lgkmcnt(7)
  v_mfma_f32_32x32x16_bf16 v[16:31], v[228:231], v[56:59], v[16:31]
  ds_read_b128 v[56:59], v7 offset:5120
  buffer_load_dwordx4 v2, s[8:11], s94 offen offset:1024 sc1 lds
  s_waitcnt lgkmcnt(7)
  v_mfma_f32_32x32x16_bf16 v[16:31], v[88:91], v[60:63], v[16:31]
  ds_read_b128 v[60:63], v7 offset:19456
  s_waitcnt lgkmcnt(7)
  v_mfma_f32_32x32x16_bf16 v[16:31], v[232:235], v[240:243], v[16:31]
  ds_read_b128 v[240:243], v7 offset:6144
  s_waitcnt lgkmcnt(7)
  v_mfma_f32_32x32x16_bf16 v[16:31], v[92:95], v[244:247], v[16:31]
  ds_read_b128 v[244:247], v7 offset:20480
  buffer_load_dwordx4 v2, s[8:11], s94 offen offset:2048 sc1 lds
  s_waitcnt lgkmcnt(7)
  v_mfma_f32_32x32x16_bf16 v[16:31], v[96:99], v[248:251], v[16:31]
  ds_read_b128 v[248:251], v7 offset:7168
  s_waitcnt lgkmcnt(7)
  v_mfma_f32_32x32x16_bf16 v[16:31], v[128:131], v[252:255], v[16:31]
  ds_read_b128 v[252:255], v7 offset:21504
  s_waitcnt vmcnt(3)
  v_cmp_ne_u32 vcc, s56, v6
  s_cbranch_vccz L_polld8
  s_mov_b32 s5, 2383872
  s_mov_b32 s6, 0
  s_cmp_lg_u32 s3, 0
  s_cbranch_scc1 L_polld8
L_poll8:
  buffer_load_dword v6, v13, s[8:11], s5 offen sc1
  s_add_u32 s6, s6, 1
  s_waitcnt vmcnt(0)
  v_cmp_ne_u32 vcc, s56, v6
  s_cbranch_vccz L_polld8
  s_sleep 1
  s_cmp_lt_u32 s6, 0x40000
  s_cbranch_scc1 L_poll8
L_polld8:
  s_barrier
  s_waitcnt lgkmcnt(7)
  v_mfma_f32_32x32x16_bf16 v[16:31], v[100:103], v[48:51], v[16:31]
  ds_read_b128 v[48:51], v7 offset:8192
  s_add_u32 s94, s78, 0
  s_add_u32 m0, s92, 0
  s_nop 0
  buffer_load_dwordx4 v2, s[8:11], s94 offen offset:0 sc1 lds
  s_waitcnt lgkmcnt(7)
  v_mfma_f32_32x32x16_bf16 v[16:31], v[132:135], v[52:55], v[16:31]
  ds_read_b128 v[52:55], v7 offset:22528
  s_waitcnt lgkmcnt(7)
  v_mfma_f32_32x32x16_bf16 v[16:31], v[104:107], v[56:59], v[16:31]
  ds_read_b128 v[56:59], v7 offset:9216
  buffer_load_dwordx4 v2, s[8:11], s94 offen offset:1024 sc1 lds
  s_waitcnt lgkmcnt(7)
  v_mfma_f32_32x32x16_bf16 v[16:31], v[136:139], v[60:63], v[16:31]
  ds_read_b128 v[60:63], v7 offset:23552
  s_waitcnt lgkmcnt(7)
  v_mfma_f32_32x32x16_bf16 v[16:31], v[108:111], v[240:243], v[16:31]
  ds_read_b128 v[240:243], v7 offset:10240
  buffer_load_dwordx4 v2, s[8:11], s94 offen offset:2048 sc1 lds
  s_waitcnt lgkmcnt(7)
  v_mfma_f32_32x32x16_bf16 v[16:31], v[140:143], v[244:247], v[16:31]
  ds_read_b128 v[244:247], v7 offset:24576
  s_waitcnt lgkmcnt(7)
  v_mfma_f32_32x32x16_bf16 v[16:31], v[112:115], v[248:251], v[16:31]
  buffer_load_dwordx4 v2, s[8:11], s94 offen offset:3072 sc1 lds
  s_waitcnt lgkmcnt(6)
  v_mfma_f32_32x32x16_bf16 v[16:31], v[144:147], v[252:255], v[16:31]
  s_waitcnt vmcnt(4)
  s_barrier
  s_waitcnt lgkmcnt(5)
  v_mfma_f32_32x32x16_bf16 v[16:31], v[116:119], v[48:51], v[16:31]
  ds_read_b128 v[248:251], v7 offset:11264
  ds_read_b128 v[252:255], v7 offset:25600
  ds_read_b128 v[48:51], v7 offset:12288
  s_add_u32 s94, s78, 4096
  s_add_u32 m0, s92, 4096
  s_nop 0
  buffer_load_dwordx4 v2, s[8:11], s94 offen offset:0 sc1 lds
  s_waitcnt lgkmcnt(7)
  v_mfma_f32_32x32x16_bf16 v[16:31], v[148:151], v[52:55], v[16:31]
  ds_read_b128 v[52:55], v7 offset:26624
  buffer_load_dwordx4 v2, s[8:11], s94 offen offset:1024 sc1 lds
  s_waitcnt lgkmcnt(7)
  v_mfma_f32_32x32x16_bf16 v[16:31], v[120:123], v[56:59], v[16:31]
  ds_read_b128 v[56:59], v7 offset:13312
  s_waitcnt lgkmcnt(7)
  v_mfma_f32_32x32x16_bf16 v[16:31], v[152:155], v[60:63], v[16:31]
  ds_read_b128 v[60:63], v7 offset:27648
  buffer_load_dwordx4 v2, s[8:11], s94 offen offset:2048 sc1 lds
  s_waitcnt lgkmcnt(7)
  v_mfma_f32_32x32x16_bf16 v[16:31], v[124:127], v[240:243], v[16:31]
  buffer_load_dwordx4 v2, s[8:11], s94 offen offset:3072 sc1 lds
  s_waitcnt lgkmcnt(6)
  v_mfma_f32_32x32x16_bf16 v[16:31], v[156:159], v[244:247], v[16:31]
  s_waitcnt vmcnt(4)
  s_barrier
  s_waitcnt lgkmcnt(5)
  v_mfma_f32_32x32x16_bf16 v[16:31], v[72:75], v[248:251], v[16:31]
  ds_read_b128 v[240:243], v7 offset:0
  ds_read_b128 v[244:247], v7 offset:14336
  ds_read_b128 v[248:251], v7 offset:1024
  s_add_u32 s94, s79, 8192
  s_add_u32 m0, s92, 8192
  s_nop 0
  buffer_load_dwordx4 v2, s[8:11], s94 offen offset:0 sc1 lds
  s_waitcnt lgkmcnt(7)
  v_mfma_f32_32x32x16_bf16 v[16:31], v[160:163], v[252:255], v[16:31]
  ds_read_b128 v[252:255], v7 offset:15360
  s_waitcnt lgkmcnt(7)
  v_mfma_f32_32x32x16_bf16 v[16:31], v[76:79], v[48:51], v[16:31]
  ds_read_b128 v[48:51], v7 offset:2048
  buffer_load_dwordx4 v2, s[8:11], s94 offen offset:1024 sc1 lds
  s_waitcnt lgkmcnt(7)
  v_mfma_f32_32x32x16_bf16 v[16:31], v[164:167], v[52:55], v[16:31]
  ds_read_b128 v[52:55], v7 offset:16384
  s_waitcnt lgkmcnt(7)
  v_mfma_f32_32x32x16_bf16 v[16:31], v[80:83], v[56:59], v[16:31]
  ds_read_b128 v[56:59], v7 offset:3072
  buffer_load_dwordx4 v2, s[8:11], s94 offen offset:2048 sc1 lds
  s_waitcnt lgkmcnt(7)
  v_mfma_f32_32x32x16_bf16 v[16:31], v[168:171], v[60:63], v[16:31]
  ds_read_b128 v[60:63], v7 offset:17408
  s_waitcnt vmcnt(3)
  s_barrier
  s_waitcnt lgkmcnt(7)
  v_mfma_f32_32x32x16_bf16 v[32:47], v[224:227], v[240:243], 0
  ds_read_b128 v[240:243], v7 offset:4096
  s_add_u32 s94, s79, 11264
  s_add_u32 m0, s92, 11264
  s_nop 0
  buffer_load_dwordx4 v2, s[8:11], s94 offen offset:0 sc1 lds
  s_waitcnt lgkmcnt(7)
  v_mfma_f32_32x32x16_bf16 v[32:47], v[84:87], v[244:247], v[32:47]
  ds_read_b128 v[244:247], v7 offset:18432
  s_waitcnt lgkmcnt(7)
  v_mfma_f32_32x32x16_bf16 v[32:47], v[228:231], v[248:251], v[32:47]
  ds_read_b128 v[248:251], v7 offset:5120
  buffer_load_dwordx4 v2, s[8:11], s94 offen offset:1024 sc1 lds
  s_waitcnt lgkmcnt(7)
  v_mfma_f32_32x32x16_bf16 v[32:47], v[88:91], v[252:255], v[32:47]
  ds_read_b128 v[252:255], v7 offset:19456
  s_waitcnt lgkmcnt(7)
  v_mfma_f32_32x32x16_bf16 v[32:47], v[232:235], v[48:51], v[32:47]
  ds_read_b128 v[48:51], v7 offset:6144
  s_waitcnt lgkmcnt(7)
  v_mfma_f32_32x32x16_bf16 v[32:47], v[92:95], v[52:55], v[32:47]
  ds_read_b128 v[52:55], v7 offset:20480
  buffer_load_dwordx4 v2, s[8:11], s94 offen offset:2048 sc1 lds
  s_waitcnt lgkmcnt(7)
  v_mfma_f32_32x32x16_bf16 v[32:47], v[96:99], v[56:59], v[32:47]
  ds_read_b128 v[56:59], v7 offset:7168
  s_waitcnt lgkmcnt(7)
  v_mfma_f32_32x32x16_bf16 v[32:47], v[128:131], v[60:63], v[32:47]
  ds_read_b128 v[60:63], v7 offset:21504
  s_waitcnt vmcnt(3)
  s_barrier
  s_waitcnt lgkmcnt(7)
  v_mfma_f32_32x32x16_bf16 v[32:47], v[100:103], v[240:243], v[32:47]
  ds_read_b128 v[240:243], v7 offset:8192
  ds_write_b128 v9, v[16:19] offset:0
  s_waitcnt lgkmcnt(8)
  v_mfma_f32_32x32x16_bf16 v[32:47], v[132:135], v[244:247], v[32:47]
  ds_read_b128 v[244:247], v7 offset:22528
  s_waitcnt lgkmcnt(8)
  v_mfma_f32_32x32x16_bf16 v[32:47], v[104:107], v[248:251], v[32:47]
  ds_read_b128 v[248:251], v7 offset:9216
  s_waitcnt lgkmcnt(8)
  v_mfma_f32_32x32x16_bf16 v[32:47], v[136:139], v[252:255], v[32:47]
  ds_read_b128 v[252:255], v7 offset:23552
  ds_write_b128 v9, v[20:23] offset:1024
  s_waitcnt lgkmcnt(9)
  v_mfma_f32_32x32x16_bf16 v[32:47], v[108:111], v[48:51], v[32:47]
  ds_read_b128 v[48:51], v7 offset:10240
  s_waitcnt lgkmcnt(9)
  v_mfma_f32_32x32x16_bf16 v[32:47], v[140:143], v[52:55], v[32:47]
  ds_read_b128 v[52:55], v7 offset:24576
  s_waitcnt lgkmcnt(9)
  v_mfma_f32_32x32x16_bf16 v[32:47], v[112:115], v[56:59], v[32:47]
  ds_write_b128 v9, v[24:27] offset:2048
  s_waitcnt lgkmcnt(9)
  v_mfma_f32_32x32x16_bf16 v[32:47], v[144:147], v[60:63], v[32:47]
  s_waitcnt vmcnt(0)
  s_barrier
  s_waitcnt lgkmcnt(8)
  v_mfma_f32_32x32x16_bf16 v[32:47], v[116:119], v[240:243], v[32:47]
  ds_read_b128 v[56:59], v7 offset:11264
  ds_read_b128 v[60:63], v7 offset:25600
  ds_read_b128 v[240:243], v7 offset:12288
  s_waitcnt lgkmcnt(9)
  v_mfma_f32_32x32x16_bf16 v[32:47], v[148:151], v[244:247], v[32:47]
  ds_read_b128 v[244:247], v7 offset:26624
  ds_write_b128 v9, v[28:31] offset:3072
  s_waitcnt lgkmcnt(10)
  v_mfma_f32_32x32x16_bf16 v[32:47], v[120:123], v[248:251], v[32:47]
  ds_read_b128 v[248:251], v7 offset:13312
  s_waitcnt lgkmcnt(10)
  v_mfma_f32_32x32x16_bf16 v[32:47], v[152:155], v[252:255], v[32:47]
  ds_read_b128 v[252:255], v7 offset:27648
  s_waitcnt lgkmcnt(9)
  v_mfma_f32_32x32x16_bf16 v[32:47], v[124:127], v[48:51], v[32:47]
  v_lshlrev_b32 v212, 16, v64
  v_and_b32 v213, 0xffff0000, v64
  v_lshlrev_b32 v214, 16, v65
  v_and_b32 v215, 0xffff0000, v65
  v_lshlrev_b32 v216, 16, v66
  v_and_b32 v217, 0xffff0000, v66
  v_lshlrev_b32 v218, 16, v67
  v_and_b32 v219, 0xffff0000, v67
  v_add_u32 v65, s95, v10
  v_add_u32 v66, s95, v65
  v_add_u32 v67, s95, v66
  s_waitcnt lgkmcnt(8)
  v_mfma_f32_32x32x16_bf16 v[32:47], v[156:159], v[52:55], v[32:47]
  s_waitcnt lgkmcnt(6)
  v_mfma_f32_32x32x16_bf16 v[32:47], v[72:75], v[56:59], v[32:47]
  s_waitcnt lgkmcnt(5)
  v_mfma_f32_32x32x16_bf16 v[32:47], v[160:163], v[60:63], v[32:47]
  s_waitcnt lgkmcnt(4)
  v_mfma_f32_32x32x16_bf16 v[32:47], v[76:79], v[240:243], v[32:47]
  s_waitcnt lgkmcnt(3)
  v_mfma_f32_32x32x16_bf16 v[32:47], v[164:167], v[244:247], v[32:47]
  s_waitcnt lgkmcnt(1)
  v_mfma_f32_32x32x16_bf16 v[32:47], v[80:83], v[248:251], v[32:47]
  s_waitcnt lgkmcnt(0)
  v_mfma_f32_32x32x16_bf16 v[32:47], v[168:171], v[252:255], v[32:47]
  s_nop 11
  ds_write_b128 v12, v[32:35] offset:0
  ds_write_b128 v12, v[36:39] offset:1024
  ds_write_b128 v12, v[40:43] offset:2048
  ds_write_b128 v12, v[44:47] offset:3072
  s_waitcnt lgkmcnt(0)
  s_barrier
  ds_read_b128 v[172:175], v10 offset:0
  ds_read_b128 v[176:179], v10 offset:1024
  ds_read_b128 v[180:183], v65 offset:0
  ds_read_b128 v[184:187], v65 offset:1024
  ds_read_b128 v[188:191], v66 offset:0
  ds_read_b128 v[192:195], v66 offset:1024
  ds_read_b128 v[196:199], v67 offset:0
  ds_read_b128 v[200:203], v67 offset:1024
  s_waitcnt lgkmcnt(7)
  v_add_f32 v172, v172, v220
  v_add_f32 v173, v173, v221
  v_add_f32 v174, v174, v222
  v_add_f32 v175, v175, v223
  s_waitcnt lgkmcnt(6)
  v_add_f32 v176, v176, v236
  v_add_f32 v177, v177, v237
  v_add_f32 v178, v178, v238
  v_add_f32 v179, v179, v239
  s_waitcnt lgkmcnt(5)
  v_add_f32 v172, v172, v180
  v_add_f32 v173, v173, v181
  v_add_f32 v174, v174, v182
  v_add_f32 v175, v175, v183
  s_waitcnt lgkmcnt(4)
  v_add_f32 v176, v176, v184
  v_add_f32 v177, v177, v185
  v_add_f32 v178, v178, v186
  v_add_f32 v179, v179, v187
  s_waitcnt lgkmcnt(1)
  v_add_f32 v188, v188, v196
  v_add_f32 v189, v189, v197
  v_add_f32 v190, v190, v198
  v_add_f32 v191, v191, v199
  s_waitcnt lgkmcnt(0)
  v_add_f32 v192, v192, v200
  v_add_f32 v193, v193, v201
  v_add_f32 v194, v194, v202
  v_add_f32 v195, v195, v203
  v_add_f32 v172, v172, v188
  v_add_f32 v173, v173, v189
  v_add_f32 v174, v174, v190
  v_add_f32 v175, v175, v191
  v_add_f32 v176, v176, v192
  v_add_f32 v177, v177, v193
  v_add_f32 v178, v178, v194
  v_add_f32 v179, v179, v195
  v_fmac_f32 v212, v172, v204
  v_fmac_f32 v213, v173, v205
  v_fmac_f32 v214, v174, v206
  v_fmac_f32 v215, v175, v207
  v_fmac_f32 v216, v176, v208
  v_fmac_f32 v217, v177, v209
  v_fmac_f32 v218, v178, v210
  v_fmac_f32 v219, v179, v211
  v_cvt_pk_bf16_f32 v172, v212, v213
  v_cvt_pk_bf16_f32 v173, v214, v215
  v_cvt_pk_bf16_f32 v174, v216, v217
  v_cvt_pk_bf16_f32 v175, v218, v219
  s_nop 0
  v_permlane32_swap_b32 v172, v174
  v_permlane32_swap_b32 v173, v175
  buffer_store_dwordx4 v[172:175], v11, s[52:55], s93 offen
L_end:
  s_endpgm

.section .rodata,"a"
.p2align 6
.amdhsa_kernel adaLN_cond__ssm_conv_h3__mixer_s_mlp__prompt_kernel
  .amdhsa_next_free_vgpr 256
  .amdhsa_next_free_sgpr 102
  .amdhsa_accum_offset 256
  .amdhsa_group_segment_fixed_size 0
  .amdhsa_kernarg_size 128
  .amdhsa_user_sgpr_count 2
  .amdhsa_user_sgpr_kernarg_segment_ptr 1
  .amdhsa_system_sgpr_workgroup_id_x 1
.end_amdhsa_kernel
```
